```python
import torch

def _softmax(x, axis=-1):
    return torch.softmax(x, dim=axis)

def _gelu(x):
    return torch.nn.functional.gelu(x, approximate='tanh')

def _silu(x):
    return torch.nn.functional.silu(x)

def _sigmoid(x):
    return torch.sigmoid(x)

def _layernorm(x, axis=-1, eps=1e-05):
    m = x.mean(dim=axis, keepdim=True)
    v = x.var(dim=axis, keepdim=True, unbiased=False)
    return (x - m) / torch.sqrt(v + eps)

def _scatter_add(tgt, idx, src, axis=0):
    return tgt.clone().index_add_(axis, idx, src)

def _segment_sum(src, seg, n):
    out = torch.zeros((n,) + src.shape[1:], dtype=src.dtype)
    return out.index_add_(0, seg, src)

def _pad(x, pw):
    flat = tuple((v for pair in reversed(pw) for v in pair))
    return torch.nn.functional.pad(x, flat)
kernel_name = 'standalone__swin_window_attn__vision'

def setup_inputs():

    _w = lambda a: (lambda t: t.to(torch.bfloat16) if t.is_floating_point() else t)(torch.as_tensor(a))
    H = W = 384 // 8 * 8
    C, win = (192, 8)
    return {'x': _w((lambda *s: torch.randn(*s, dtype=torch.bfloat16) * 0.2)(1, H, W, C)), 'wqkv': _w((lambda *s: torch.randn(*s, dtype=torch.bfloat16) * 0.2)(C, 3 * C)), 'wo': _w((lambda *s: torch.randn(*s, dtype=torch.bfloat16) * 0.05)(C, C))}

def reference(x, wqkv, wo):
    B, H, W, C = x.shape
    win = 8
    nh, nw = (H // win, W // win)
    xw = (lambda x, *d: x.permute(*d))(x.reshape(B, nh, win, nw, win, C), 0, 1, 3, 2, 4, 5)
    xw = xw.reshape(B * nh * nw, win * win, C)
    qkv = xw @ wqkv
    q, k, v = (qkv[..., :C].clone(), qkv[..., C:2 * C].clone(), qkv[..., 2 * C:].clone())
    scale = C ** (-0.5)
    p = _softmax(torch.einsum('bqc,bkc->bqk', q, k) * scale, axis=-1)
    o = torch.einsum('bqk,bkc->bqc', p, v) @ wo
    o = (lambda x, *d: x.permute(*d))(o.reshape(B, nh, nw, win, win, C), 0, 1, 3, 2, 4, 5)
    return o.reshape(B, H, W, C)
```

```asm
; @launch kernel=swin_fold_kernel grid=(144,1,1) block=(64,1,1) lds=0
; @launch kernel=standalone__swin_window_attn__vision_kernel grid=(256,1,1) block=(512,1,1) lds=147456
.amdgcn_target "amdgcn-amd-amdhsa--gfx950"
.text
.globl swin_fold_kernel
.p2align 8
.type swin_fold_kernel,@function
swin_fold_kernel:
    s_cmp_ge_u32 s2, 144
    s_cbranch_scc1 L_fold_done
    s_load_dwordx4 s[4:7], s[0:1], 8
    s_load_dwordx2 s[8:9], s[0:1], 40
    v_and_b32 v2, 15, v0
    v_lshrrev_b32 v3, 4, v0
    v_lshrrev_b32 v4, 2, v2
    v_lshlrev_b32 v4, 3, v4
    v_and_b32 v5, 3, v2
    v_add_u32 v4, v4, v5
    v_lshlrev_b32 v5, 4, v3
    v_lshlrev_b32 v6, 4, v0
    s_movk_i32 s39, 1152
    s_mul_i32 s26, s2, 43691
    s_lshr_b32 s26, s26, 19
    s_mul_i32 s27, s26, 12
    s_sub_u32 s27, s2, s27
    s_cmp_ge_u32 s27, 6
    s_cselect_b32 s28, 1, 0
    s_mul_i32 s29, s28, 6
    s_sub_u32 s29, s27, s29
    s_cmp_ge_u32 s26, 6
    s_cselect_b32 s30, 1, 0
    s_mul_i32 s31, s30, 6
    s_sub_u32 s31, s26, s31
    s_lshl_b32 s31, s31, 5
    s_lshl_b32 s32, s28, 2
    s_add_u32 s31, s31, s32
    s_lshl_b32 s32, s29, 5
    s_mul_i32 s33, s30, 768
    s_lshl_b32 s34, s2, 10
    v_add_u32 v8, s32, v4
    v_mul_lo_u32 v8, v8, s39
    v_add_u32 v8, v8, v5
    v_add_u32 v8, s33, v8
    v_add_u32 v9, 4608, v8
    v_add_u32 v12, s31, v4
    v_mul_lo_u32 v13, v12, s39
    v_add_u32 v13, v13, v5
    s_mul_i32 s40, s30, 6
    s_sub_u32 s40, s26, s40
    s_lshl_b32 s40, s40, 1
    s_add_u32 s40, s40, s28
    s_add_u32 s41, s40, 120
    s_cmp_ge_u32 s40, 8
    s_cselect_b32 s41, s41, s40
    s_cselect_b32 s42, 2, 3
    v_lshlrev_b32 v15, s42, v2
    v_add_u32 v15, s41, v15
    v_mul_u32_u24 v14, 3072, v3
    v_lshl_add_u32 v14, v15, 1, v14
    s_waitcnt lgkmcnt(0)
    s_mov_b32 s12, s4
    s_mov_b32 s13, s5
    s_mov_b32 s14, 221184
    s_mov_b32 s15, 0x00020000
    s_mov_b32 s16, s6
    s_mov_b32 s17, s7
    s_mov_b32 s18, 73728
    s_mov_b32 s19, 0x00020000
    s_mov_b32 s20, s8
    s_mov_b32 s21, s9
    s_mov_b32 s22, 147456
    s_mov_b32 s23, 0x00020000
    s_cmp_eq_u32 s30, 1
    s_cbranch_scc1 L_fold_v
    buffer_load_dwordx4 v[96:99], v8, s[12:15], 0 offen offset:0
    buffer_load_dwordx4 v[120:123], v9, s[12:15], 0 offen offset:0
    buffer_load_dwordx4 v[100:103], v8, s[12:15], 0 offen offset:64
    buffer_load_dwordx4 v[124:127], v9, s[12:15], 0 offen offset:64
    buffer_load_dwordx4 v[104:107], v8, s[12:15], 0 offen offset:128
    buffer_load_dwordx4 v[128:131], v9, s[12:15], 0 offen offset:128
    buffer_load_dwordx4 v[108:111], v8, s[12:15], 0 offen offset:192
    buffer_load_dwordx4 v[132:135], v9, s[12:15], 0 offen offset:192
    buffer_load_dwordx4 v[112:115], v8, s[12:15], 0 offen offset:256
    buffer_load_dwordx4 v[136:139], v9, s[12:15], 0 offen offset:256
    buffer_load_dwordx4 v[116:119], v8, s[12:15], 0 offen offset:320
    buffer_load_dwordx4 v[140:143], v9, s[12:15], 0 offen offset:320
    buffer_load_dwordx4 v[16:19], v13, s[12:15], 0 offen offset:384
    buffer_load_dwordx4 v[20:23], v13, s[12:15], 0 offen offset:448
    buffer_load_dwordx4 v[24:27], v13, s[12:15], 0 offen offset:512
    buffer_load_dwordx4 v[28:31], v13, s[12:15], 0 offen offset:576
    buffer_load_dwordx4 v[32:35], v13, s[12:15], 0 offen offset:640
    buffer_load_dwordx4 v[36:39], v13, s[12:15], 0 offen offset:704
    s_mov_b32 s35, 0x3dd53b95
    s_branch L_fold_mm
L_fold_v:
    s_mov_b32 s35, 0
    buffer_load_ushort v40, v14, s[16:19], s35 offen offset:0
    buffer_load_ushort v41, v14, s[16:19], s35 offen offset:384
    buffer_load_ushort v42, v14, s[16:19], s35 offen offset:768
    buffer_load_ushort v43, v14, s[16:19], s35 offen offset:1152
    buffer_load_ushort v44, v14, s[16:19], s35 offen offset:1536
    buffer_load_ushort v45, v14, s[16:19], s35 offen offset:1920
    buffer_load_ushort v46, v14, s[16:19], s35 offen offset:2304
    buffer_load_ushort v47, v14, s[16:19], s35 offen offset:2688
    s_mov_b32 s35, 12288
    buffer_load_ushort v48, v14, s[16:19], s35 offen offset:0
    buffer_load_ushort v49, v14, s[16:19], s35 offen offset:384
    buffer_load_ushort v50, v14, s[16:19], s35 offen offset:768
    buffer_load_ushort v51, v14, s[16:19], s35 offen offset:1152
    buffer_load_ushort v52, v14, s[16:19], s35 offen offset:1536
    buffer_load_ushort v53, v14, s[16:19], s35 offen offset:1920
    buffer_load_ushort v54, v14, s[16:19], s35 offen offset:2304
    buffer_load_ushort v55, v14, s[16:19], s35 offen offset:2688
    s_mov_b32 s35, 24576
    buffer_load_ushort v56, v14, s[16:19], s35 offen offset:0
    buffer_load_ushort v57, v14, s[16:19], s35 offen offset:384
    buffer_load_ushort v58, v14, s[16:19], s35 offen offset:768
    buffer_load_ushort v59, v14, s[16:19], s35 offen offset:1152
    buffer_load_ushort v60, v14, s[16:19], s35 offen offset:1536
    buffer_load_ushort v61, v14, s[16:19], s35 offen offset:1920
    buffer_load_ushort v62, v14, s[16:19], s35 offen offset:2304
    buffer_load_ushort v63, v14, s[16:19], s35 offen offset:2688
    s_mov_b32 s35, 36864
    buffer_load_ushort v64, v14, s[16:19], s35 offen offset:0
    buffer_load_ushort v65, v14, s[16:19], s35 offen offset:384
    buffer_load_ushort v66, v14, s[16:19], s35 offen offset:768
    buffer_load_ushort v67, v14, s[16:19], s35 offen offset:1152
    buffer_load_ushort v68, v14, s[16:19], s35 offen offset:1536
    buffer_load_ushort v69, v14, s[16:19], s35 offen offset:1920
    buffer_load_ushort v70, v14, s[16:19], s35 offen offset:2304
    buffer_load_ushort v71, v14, s[16:19], s35 offen offset:2688
    s_mov_b32 s35, 49152
    buffer_load_ushort v72, v14, s[16:19], s35 offen offset:0
    buffer_load_ushort v73, v14, s[16:19], s35 offen offset:384
    buffer_load_ushort v74, v14, s[16:19], s35 offen offset:768
    buffer_load_ushort v75, v14, s[16:19], s35 offen offset:1152
    buffer_load_ushort v76, v14, s[16:19], s35 offen offset:1536
    buffer_load_ushort v77, v14, s[16:19], s35 offen offset:1920
    buffer_load_ushort v78, v14, s[16:19], s35 offen offset:2304
    buffer_load_ushort v79, v14, s[16:19], s35 offen offset:2688
    s_mov_b32 s35, 61440
    buffer_load_ushort v80, v14, s[16:19], s35 offen offset:0
    buffer_load_ushort v81, v14, s[16:19], s35 offen offset:384
    buffer_load_ushort v82, v14, s[16:19], s35 offen offset:768
    buffer_load_ushort v83, v14, s[16:19], s35 offen offset:1152
    buffer_load_ushort v84, v14, s[16:19], s35 offen offset:1536
    buffer_load_ushort v85, v14, s[16:19], s35 offen offset:1920
    buffer_load_ushort v86, v14, s[16:19], s35 offen offset:2304
    buffer_load_ushort v87, v14, s[16:19], s35 offen offset:2688
    buffer_load_dwordx4 v[96:99], v8, s[12:15], 0 offen offset:0
    buffer_load_dwordx4 v[120:123], v9, s[12:15], 0 offen offset:0
    buffer_load_dwordx4 v[100:103], v8, s[12:15], 0 offen offset:64
    buffer_load_dwordx4 v[124:127], v9, s[12:15], 0 offen offset:64
    buffer_load_dwordx4 v[104:107], v8, s[12:15], 0 offen offset:128
    buffer_load_dwordx4 v[128:131], v9, s[12:15], 0 offen offset:128
    buffer_load_dwordx4 v[108:111], v8, s[12:15], 0 offen offset:192
    buffer_load_dwordx4 v[132:135], v9, s[12:15], 0 offen offset:192
    buffer_load_dwordx4 v[112:115], v8, s[12:15], 0 offen offset:256
    buffer_load_dwordx4 v[136:139], v9, s[12:15], 0 offen offset:256
    buffer_load_dwordx4 v[116:119], v8, s[12:15], 0 offen offset:320
    buffer_load_dwordx4 v[140:143], v9, s[12:15], 0 offen offset:320
    s_mov_b32 s35, 1.0
    s_waitcnt vmcnt(12)
    v_lshl_or_b32 v16, v41, 16, v40
    v_lshl_or_b32 v17, v43, 16, v42
    v_lshl_or_b32 v18, v45, 16, v44
    v_lshl_or_b32 v19, v47, 16, v46
    v_lshl_or_b32 v20, v49, 16, v48
    v_lshl_or_b32 v21, v51, 16, v50
    v_lshl_or_b32 v22, v53, 16, v52
    v_lshl_or_b32 v23, v55, 16, v54
    v_lshl_or_b32 v24, v57, 16, v56
    v_lshl_or_b32 v25, v59, 16, v58
    v_lshl_or_b32 v26, v61, 16, v60
    v_lshl_or_b32 v27, v63, 16, v62
    v_lshl_or_b32 v28, v65, 16, v64
    v_lshl_or_b32 v29, v67, 16, v66
    v_lshl_or_b32 v30, v69, 16, v68
    v_lshl_or_b32 v31, v71, 16, v70
    v_lshl_or_b32 v32, v73, 16, v72
    v_lshl_or_b32 v33, v75, 16, v74
    v_lshl_or_b32 v34, v77, 16, v76
    v_lshl_or_b32 v35, v79, 16, v78
    v_lshl_or_b32 v36, v81, 16, v80
    v_lshl_or_b32 v37, v83, 16, v82
    v_lshl_or_b32 v38, v85, 16, v84
    v_lshl_or_b32 v39, v87, 16, v86
    s_nop 1
L_fold_mm:
    s_waitcnt vmcnt(0)
    v_mfma_f32_16x16x32_bf16 v[40:43], v[96:99], v[16:19], 0
    v_mfma_f32_16x16x32_bf16 v[44:47], v[120:123], v[16:19], 0
    v_mfma_f32_16x16x32_bf16 v[40:43], v[100:103], v[20:23], v[40:43]
    v_mfma_f32_16x16x32_bf16 v[44:47], v[124:127], v[20:23], v[44:47]
    v_mfma_f32_16x16x32_bf16 v[40:43], v[104:107], v[24:27], v[40:43]
    v_mfma_f32_16x16x32_bf16 v[44:47], v[128:131], v[24:27], v[44:47]
    v_mfma_f32_16x16x32_bf16 v[40:43], v[108:111], v[28:31], v[40:43]
    v_mfma_f32_16x16x32_bf16 v[44:47], v[132:135], v[28:31], v[44:47]
    v_mfma_f32_16x16x32_bf16 v[40:43], v[112:115], v[32:35], v[40:43]
    v_mfma_f32_16x16x32_bf16 v[44:47], v[136:139], v[32:35], v[44:47]
    v_mfma_f32_16x16x32_bf16 v[40:43], v[116:119], v[36:39], v[40:43]
    v_mfma_f32_16x16x32_bf16 v[44:47], v[140:143], v[36:39], v[44:47]
    s_nop 3
    v_mul_f32 v40, s35, v40
    v_mul_f32 v41, s35, v41
    v_mul_f32 v42, s35, v42
    v_mul_f32 v43, s35, v43
    v_mul_f32 v44, s35, v44
    v_mul_f32 v45, s35, v45
    v_mul_f32 v46, s35, v46
    v_mul_f32 v47, s35, v47
    v_cvt_pk_bf16_f32 v48, v40, v41
    v_cvt_pk_bf16_f32 v49, v42, v43
    v_cvt_pk_bf16_f32 v50, v44, v45
    v_cvt_pk_bf16_f32 v51, v46, v47
    buffer_store_dwordx4 v[48:51], v6, s[20:23], s34 offen offset:0
L_fold_done:
    s_endpgm
.globl standalone__swin_window_attn__vision_kernel
.p2align 8
.type standalone__swin_window_attn__vision_kernel,@function
standalone__swin_window_attn__vision_kernel:
    s_cmp_ge_u32 s2, 256
    s_cbranch_scc1 L_main_done
    s_load_dwordx2 s[26:27], s[0:1], 0
    s_load_dwordx2 s[28:29], s[0:1], 24
    s_load_dwordx2 s[30:31], s[0:1], 40
    s_mov_b32 s24, s2
    v_lshrrev_b32 v40, 6, v0
    v_and_b32 v41, 63, v0
    v_readfirstlane_b32 s37, v40
    s_and_b32 s16, s37, 3
    s_waitcnt lgkmcnt(0)
    s_mov_b32 s4, s26
    s_mov_b32 s5, s27
    s_mov_b32 s6, 56623104
    s_mov_b32 s7, 0x00020000
    s_mov_b32 s8, s28
    s_mov_b32 s9, s29
    s_mov_b32 s10, 56623104
    s_mov_b32 s11, 0x00020000
    s_mov_b32 s12, s30
    s_mov_b32 s13, s31
    s_mov_b32 s14, 147456
    s_mov_b32 s15, 0x00020000
    s_cmp_ge_u32 s37, 4
    s_cbranch_scc1 L_B_role
    v_and_b32 v8, 63, v0
    v_lshlrev_b32 v13, 4, v8
    s_lshl_b32 s26, s16, 1
    s_add_u32 s27, s16, 2
    s_add_u32 s29, s26, 1
    s_add_u32 s30, s26, 4
    s_add_u32 s31, s16, 6
    s_add_u32 s32, s26, 5
    s_cmp_ge_u32 s16, 2
    s_cselect_b32 s28, s27, s26
    s_cselect_b32 s29, s30, s29
    s_cselect_b32 s30, s32, s31
    s_mul_i32 s60, s28, 12288
    s_add_u32 s61, s60, 4096
    s_add_u32 s62, s60, 8192
    s_mul_i32 s63, s29, 12288
    s_add_u32 s64, s63, 4096
    s_add_u32 s65, s63, 8192
    s_mul_i32 s66, s30, 12288
    s_add_u32 s67, s66, 4096
    s_add_u32 s68, s66, 8192
    v_mov_b32 v3, v13
    v_and_b32 v9, 15, v8
    v_lshrrev_b32 v10, 4, v8
    v_lshrrev_b32 v12, 1, v9
    v_mul_u32_u24 v14, 384, v9
    v_xor_b32 v15, v10, v12
    v_lshl_add_u32 v1, v15, 4, v14
    v_xor_b32 v15, 4, v15
    v_lshl_add_u32 v2, v15, 4, v14
    s_lshl_b32 s34, s28, 10
    s_add_u32 s34, s34, 73728
    v_add_u32 v5, s34, v13
    s_cmp_ge_u32 s16, 2
    s_cselect_b32 s34, s29, s30
    s_sub_u32 s34, s34, 6
    s_lshl_b32 s34, s34, 12
    s_add_u32 s34, s34, 98304
    v_add_u32 v6, s34, v13
    s_mov_b32 s20, 0
    s_mov_b32 s21, 4294942720
    s_mov_b32 s17, 0
    s_cmp_ge_u32 s16, 2
    s_cbranch_scc1 L_A_23
    s_setprio 1
    buffer_load_dwordx4 a[0:3], v3, s[12:15], s60 offen offset:0
    buffer_load_dwordx4 a[24:27], v3, s[12:15], s61 offen offset:2048
    buffer_load_dwordx4 a[4:7], v3, s[12:15], s60 offen offset:1024
    buffer_load_dwordx4 a[28:31], v3, s[12:15], s61 offen offset:3072
    buffer_load_dwordx4 a[8:11], v3, s[12:15], s60 offen offset:2048
    buffer_load_dwordx4 a[32:35], v3, s[12:15], s62 offen offset:0
    buffer_load_dwordx4 a[12:15], v3, s[12:15], s60 offen offset:3072
    buffer_load_dwordx4 a[36:39], v3, s[12:15], s62 offen offset:1024
    buffer_load_dwordx4 a[16:19], v3, s[12:15], s61 offen offset:0
    buffer_load_dwordx4 a[40:43], v3, s[12:15], s62 offen offset:2048
    buffer_load_dwordx4 a[20:23], v3, s[12:15], s61 offen offset:1024
    buffer_load_dwordx4 a[44:47], v3, s[12:15], s62 offen offset:3072
    buffer_load_dwordx4 a[48:51], v3, s[12:15], s63 offen offset:0
    buffer_load_dwordx4 a[72:75], v3, s[12:15], s64 offen offset:2048
    buffer_load_dwordx4 a[52:55], v3, s[12:15], s63 offen offset:1024
    buffer_load_dwordx4 a[76:79], v3, s[12:15], s64 offen offset:3072
    buffer_load_dwordx4 a[56:59], v3, s[12:15], s63 offen offset:2048
    buffer_load_dwordx4 a[80:83], v3, s[12:15], s65 offen offset:0
    buffer_load_dwordx4 a[60:63], v3, s[12:15], s63 offen offset:3072
    buffer_load_dwordx4 a[84:87], v3, s[12:15], s65 offen offset:1024
    buffer_load_dwordx4 a[64:67], v3, s[12:15], s64 offen offset:0
    buffer_load_dwordx4 a[88:91], v3, s[12:15], s65 offen offset:2048
    buffer_load_dwordx4 a[68:71], v3, s[12:15], s64 offen offset:1024
    buffer_load_dwordx4 a[92:95], v3, s[12:15], s65 offen offset:3072
    buffer_load_dwordx4 a[96:99], v3, s[12:15], s66 offen offset:0
    buffer_load_dwordx4 a[120:123], v3, s[12:15], s67 offen offset:2048
    buffer_load_dwordx4 a[100:103], v3, s[12:15], s66 offen offset:1024
    buffer_load_dwordx4 a[124:127], v3, s[12:15], s67 offen offset:3072
    buffer_load_dwordx4 a[104:107], v3, s[12:15], s66 offen offset:2048
    buffer_load_dwordx4 a[128:131], v3, s[12:15], s68 offen offset:0
    buffer_load_dwordx4 a[108:111], v3, s[12:15], s66 offen offset:3072
    buffer_load_dwordx4 a[132:135], v3, s[12:15], s68 offen offset:1024
    buffer_load_dwordx4 a[112:115], v3, s[12:15], s67 offen offset:0
    buffer_load_dwordx4 a[136:139], v3, s[12:15], s68 offen offset:2048
    buffer_load_dwordx4 a[116:119], v3, s[12:15], s67 offen offset:1024
    buffer_load_dwordx4 a[140:143], v3, s[12:15], s68 offen offset:3072
    s_barrier
    ds_read_b128 a[144:147], v1 offset:0
    ds_read_b128 a[148:151], v2 offset:0
    ds_read_b128 a[152:155], v1 offset:128
    ds_read_b128 a[156:159], v2 offset:128
    ds_read_b128 v[56:59], v1 offset:256
    ds_read_b128 v[60:63], v2 offset:256
    ds_read_b128 v[64:67], v1 offset:6144
    ds_read_b128 v[68:71], v2 offset:6144
    ds_read_b128 v[72:75], v1 offset:6272
    ds_read_b128 v[76:79], v2 offset:6272
    ds_read_b128 v[80:83], v1 offset:6400
    ds_read_b128 v[84:87], v2 offset:6400
    s_waitcnt vmcnt(35) lgkmcnt(11)
    v_mfma_f32_16x16x32_bf16 v[24:27], a[0:3], a[144:147], 0
    s_waitcnt vmcnt(34)
    v_mfma_f32_16x16x32_bf16 v[28:31], a[24:27], a[144:147], 0
    s_waitcnt lgkmcnt(5)
    v_mfma_f32_16x16x32_bf16 v[32:35], a[0:3], v[64:67], 0
    v_mfma_f32_16x16x32_bf16 v[36:39], a[24:27], v[64:67], 0
    s_waitcnt vmcnt(33)
    v_mfma_f32_16x16x32_bf16 v[24:27], a[4:7], a[148:151], v[24:27]
    s_waitcnt vmcnt(32)
    v_mfma_f32_16x16x32_bf16 v[28:31], a[28:31], a[148:151], v[28:31]
    s_waitcnt lgkmcnt(4)
    v_mfma_f32_16x16x32_bf16 v[32:35], a[4:7], v[68:71], v[32:35]
    v_mfma_f32_16x16x32_bf16 v[36:39], a[28:31], v[68:71], v[36:39]
    s_waitcnt vmcnt(31)
    v_mfma_f32_16x16x32_bf16 v[24:27], a[8:11], a[152:155], v[24:27]
    s_waitcnt vmcnt(30)
    v_mfma_f32_16x16x32_bf16 v[28:31], a[32:35], a[152:155], v[28:31]
    s_waitcnt lgkmcnt(3)
    v_mfma_f32_16x16x32_bf16 v[32:35], a[8:11], v[72:75], v[32:35]
    v_mfma_f32_16x16x32_bf16 v[36:39], a[32:35], v[72:75], v[36:39]
    s_waitcnt vmcnt(29)
    v_mfma_f32_16x16x32_bf16 v[24:27], a[12:15], a[156:159], v[24:27]
    s_waitcnt vmcnt(28)
    v_mfma_f32_16x16x32_bf16 v[28:31], a[36:39], a[156:159], v[28:31]
    s_waitcnt lgkmcnt(2)
    v_mfma_f32_16x16x32_bf16 v[32:35], a[12:15], v[76:79], v[32:35]
    v_mfma_f32_16x16x32_bf16 v[36:39], a[36:39], v[76:79], v[36:39]
    s_waitcnt vmcnt(27)
    v_mfma_f32_16x16x32_bf16 v[24:27], a[16:19], v[56:59], v[24:27]
    s_waitcnt vmcnt(26)
    v_mfma_f32_16x16x32_bf16 v[28:31], a[40:43], v[56:59], v[28:31]
    s_waitcnt lgkmcnt(1)
    v_mfma_f32_16x16x32_bf16 v[32:35], a[16:19], v[80:83], v[32:35]
    v_mfma_f32_16x16x32_bf16 v[36:39], a[40:43], v[80:83], v[36:39]
    s_waitcnt vmcnt(25)
    v_mfma_f32_16x16x32_bf16 v[24:27], a[20:23], v[60:63], v[24:27]
    s_waitcnt vmcnt(24)
    v_mfma_f32_16x16x32_bf16 v[28:31], a[44:47], v[60:63], v[28:31]
    s_waitcnt lgkmcnt(0)
    v_mfma_f32_16x16x32_bf16 v[32:35], a[20:23], v[84:87], v[32:35]
    v_mfma_f32_16x16x32_bf16 v[36:39], a[44:47], v[84:87], v[36:39]
    s_waitcnt vmcnt(23)
    v_mfma_f32_16x16x32_bf16 v[8:11], a[48:51], a[144:147], 0
    s_waitcnt vmcnt(22)
    v_mfma_f32_16x16x32_bf16 v[12:15], a[72:75], a[144:147], 0
    v_mfma_f32_16x16x32_bf16 v[16:19], a[48:51], v[64:67], 0
    v_cvt_pk_bf16_f32 v48, v24, v25
    v_cvt_pk_bf16_f32 v49, v26, v27
    v_mfma_f32_16x16x32_bf16 v[20:23], a[72:75], v[64:67], 0
    v_cvt_pk_bf16_f32 v50, v28, v29
    v_cvt_pk_bf16_f32 v51, v30, v31
    s_waitcnt vmcnt(21)
    v_mfma_f32_16x16x32_bf16 v[8:11], a[52:55], a[148:151], v[8:11]
    ds_write_b128 v5, v[48:51] offset:0
    v_cvt_pk_bf16_f32 v52, v32, v33
    s_waitcnt vmcnt(20)
    v_mfma_f32_16x16x32_bf16 v[12:15], a[76:79], a[148:151], v[12:15]
    v_cvt_pk_bf16_f32 v53, v34, v35
    v_cvt_pk_bf16_f32 v54, v36, v37
    v_mfma_f32_16x16x32_bf16 v[16:19], a[52:55], v[68:71], v[16:19]
    v_cvt_pk_bf16_f32 v55, v38, v39
    ds_write_b128 v5, v[52:55] offset:6144
    v_mfma_f32_16x16x32_bf16 v[20:23], a[76:79], v[68:71], v[20:23]
    s_waitcnt vmcnt(19)
    v_mfma_f32_16x16x32_bf16 v[8:11], a[56:59], a[152:155], v[8:11]
    s_waitcnt vmcnt(18)
    v_mfma_f32_16x16x32_bf16 v[12:15], a[80:83], a[152:155], v[12:15]
    v_mfma_f32_16x16x32_bf16 v[16:19], a[56:59], v[72:75], v[16:19]
    v_mfma_f32_16x16x32_bf16 v[20:23], a[80:83], v[72:75], v[20:23]
    s_waitcnt vmcnt(17)
    v_mfma_f32_16x16x32_bf16 v[8:11], a[60:63], a[156:159], v[8:11]
    s_waitcnt vmcnt(16)
    v_mfma_f32_16x16x32_bf16 v[12:15], a[84:87], a[156:159], v[12:15]
    v_mfma_f32_16x16x32_bf16 v[16:19], a[60:63], v[76:79], v[16:19]
    v_mfma_f32_16x16x32_bf16 v[20:23], a[84:87], v[76:79], v[20:23]
    s_waitcnt vmcnt(15)
    v_mfma_f32_16x16x32_bf16 v[8:11], a[64:67], v[56:59], v[8:11]
    s_waitcnt vmcnt(14)
    v_mfma_f32_16x16x32_bf16 v[12:15], a[88:91], v[56:59], v[12:15]
    v_mfma_f32_16x16x32_bf16 v[16:19], a[64:67], v[80:83], v[16:19]
    v_mfma_f32_16x16x32_bf16 v[20:23], a[88:91], v[80:83], v[20:23]
    s_waitcnt vmcnt(13)
    v_mfma_f32_16x16x32_bf16 v[8:11], a[68:71], v[60:63], v[8:11]
    s_waitcnt vmcnt(12)
    v_mfma_f32_16x16x32_bf16 v[12:15], a[92:95], v[60:63], v[12:15]
    v_mfma_f32_16x16x32_bf16 v[16:19], a[68:71], v[84:87], v[16:19]
    v_mfma_f32_16x16x32_bf16 v[20:23], a[92:95], v[84:87], v[20:23]
    s_waitcnt vmcnt(11)
    v_mfma_f32_16x16x32_bf16 v[24:27], a[144:147], a[96:99], 0
    s_waitcnt vmcnt(10)
    v_mfma_f32_16x16x32_bf16 v[32:35], a[144:147], a[120:123], 0
    ds_read_b128 a[144:147], v1 offset:12288
    v_mfma_f32_16x16x32_bf16 v[28:31], v[64:67], a[96:99], 0
    v_cvt_pk_bf16_f32 v40, v8, v9
    v_cvt_pk_bf16_f32 v41, v10, v11
    v_mfma_f32_16x16x32_bf16 v[36:39], v[64:67], a[120:123], 0
    ds_read_b128 v[64:67], v1 offset:18432
    v_cvt_pk_bf16_f32 v42, v12, v13
    s_waitcnt vmcnt(9)
    v_mfma_f32_16x16x32_bf16 v[24:27], a[148:151], a[100:103], v[24:27]
    v_cvt_pk_bf16_f32 v43, v14, v15
    ds_write_b128 v5, v[40:43] offset:1024
    s_waitcnt vmcnt(8)
    v_mfma_f32_16x16x32_bf16 v[32:35], a[148:151], a[124:127], v[32:35]
    ds_read_b128 a[148:151], v2 offset:12288
    v_cvt_pk_bf16_f32 v44, v16, v17
    v_mfma_f32_16x16x32_bf16 v[28:31], v[68:71], a[100:103], v[28:31]
    v_cvt_pk_bf16_f32 v45, v18, v19
    v_cvt_pk_bf16_f32 v46, v20, v21
    v_mfma_f32_16x16x32_bf16 v[36:39], v[68:71], a[124:127], v[36:39]
    ds_read_b128 v[68:71], v2 offset:18432
    v_cvt_pk_bf16_f32 v47, v22, v23
    s_waitcnt vmcnt(7)
    v_mfma_f32_16x16x32_bf16 v[24:27], a[152:155], a[104:107], v[24:27]
    ds_write_b128 v5, v[44:47] offset:7168
    s_waitcnt vmcnt(6)
    v_mfma_f32_16x16x32_bf16 v[32:35], a[152:155], a[128:131], v[32:35]
    ds_read_b128 a[152:155], v1 offset:12416
    v_mfma_f32_16x16x32_bf16 v[28:31], v[72:75], a[104:107], v[28:31]
    v_mfma_f32_16x16x32_bf16 v[36:39], v[72:75], a[128:131], v[36:39]
    ds_read_b128 v[72:75], v1 offset:18560
    s_waitcnt vmcnt(5)
    v_mfma_f32_16x16x32_bf16 v[24:27], a[156:159], a[108:111], v[24:27]
    s_waitcnt vmcnt(4)
    v_mfma_f32_16x16x32_bf16 v[32:35], a[156:159], a[132:135], v[32:35]
    ds_read_b128 a[156:159], v2 offset:12416
    v_mfma_f32_16x16x32_bf16 v[28:31], v[76:79], a[108:111], v[28:31]
    v_mfma_f32_16x16x32_bf16 v[36:39], v[76:79], a[132:135], v[36:39]
    ds_read_b128 v[76:79], v2 offset:18560
    s_waitcnt vmcnt(3)
    v_mfma_f32_16x16x32_bf16 v[24:27], v[56:59], a[112:115], v[24:27]
    s_waitcnt vmcnt(2)
    v_mfma_f32_16x16x32_bf16 v[32:35], v[56:59], a[136:139], v[32:35]
    ds_read_b128 v[56:59], v1 offset:12544
    v_mfma_f32_16x16x32_bf16 v[28:31], v[80:83], a[112:115], v[28:31]
    v_mfma_f32_16x16x32_bf16 v[36:39], v[80:83], a[136:139], v[36:39]
    ds_read_b128 v[80:83], v1 offset:18688
    s_waitcnt vmcnt(1)
    v_mfma_f32_16x16x32_bf16 v[24:27], v[60:63], a[116:119], v[24:27]
    s_waitcnt vmcnt(0)
    v_mfma_f32_16x16x32_bf16 v[32:35], v[60:63], a[140:143], v[32:35]
    ds_read_b128 v[60:63], v2 offset:12544
    v_mfma_f32_16x16x32_bf16 v[28:31], v[84:87], a[116:119], v[28:31]
    v_mfma_f32_16x16x32_bf16 v[36:39], v[84:87], a[140:143], v[36:39]
    ds_read_b128 v[84:87], v2 offset:18688
    s_waitcnt lgkmcnt(13)
    v_mfma_f32_16x16x32_bf16 v[8:11], a[0:3], a[144:147], 0
    v_mfma_f32_16x16x32_bf16 v[12:15], a[24:27], a[144:147], 0
    s_waitcnt lgkmcnt(12)
    v_mfma_f32_16x16x32_bf16 v[16:19], a[0:3], v[64:67], 0
    v_cvt_pk_bf16_f32 v48, v24, v25
    v_cvt_pk_bf16_f32 v49, v26, v27
    v_mfma_f32_16x16x32_bf16 v[20:23], a[24:27], v[64:67], 0
    v_cvt_pk_bf16_f32 v50, v28, v29
    v_cvt_pk_bf16_f32 v51, v30, v31
    s_waitcnt lgkmcnt(10)
    v_mfma_f32_16x16x32_bf16 v[8:11], a[4:7], a[148:151], v[8:11]
    ds_write_b128 v6, v[48:51] offset:0
    v_cvt_pk_bf16_f32 v52, v32, v33
    v_mfma_f32_16x16x32_bf16 v[12:15], a[28:31], a[148:151], v[12:15]
    v_cvt_pk_bf16_f32 v53, v34, v35
    v_cvt_pk_bf16_f32 v54, v36, v37
    s_waitcnt lgkmcnt(10)
    v_mfma_f32_16x16x32_bf16 v[16:19], a[4:7], v[68:71], v[16:19]
    v_cvt_pk_bf16_f32 v55, v38, v39
    ds_write_b128 v6, v[52:55] offset:2048
    v_mfma_f32_16x16x32_bf16 v[20:23], a[28:31], v[68:71], v[20:23]
    s_waitcnt lgkmcnt(9)
    v_mfma_f32_16x16x32_bf16 v[8:11], a[8:11], a[152:155], v[8:11]
    v_mfma_f32_16x16x32_bf16 v[12:15], a[32:35], a[152:155], v[12:15]
    s_waitcnt lgkmcnt(8)
    v_mfma_f32_16x16x32_bf16 v[16:19], a[8:11], v[72:75], v[16:19]
    v_mfma_f32_16x16x32_bf16 v[20:23], a[32:35], v[72:75], v[20:23]
    s_waitcnt lgkmcnt(7)
    v_mfma_f32_16x16x32_bf16 v[8:11], a[12:15], a[156:159], v[8:11]
    v_mfma_f32_16x16x32_bf16 v[12:15], a[36:39], a[156:159], v[12:15]
    s_waitcnt lgkmcnt(6)
    v_mfma_f32_16x16x32_bf16 v[16:19], a[12:15], v[76:79], v[16:19]
    v_mfma_f32_16x16x32_bf16 v[20:23], a[36:39], v[76:79], v[20:23]
    s_waitcnt lgkmcnt(5)
    v_mfma_f32_16x16x32_bf16 v[8:11], a[16:19], v[56:59], v[8:11]
    v_mfma_f32_16x16x32_bf16 v[12:15], a[40:43], v[56:59], v[12:15]
    s_waitcnt lgkmcnt(4)
    v_mfma_f32_16x16x32_bf16 v[16:19], a[16:19], v[80:83], v[16:19]
    v_mfma_f32_16x16x32_bf16 v[20:23], a[40:43], v[80:83], v[20:23]
    s_waitcnt lgkmcnt(3)
    v_mfma_f32_16x16x32_bf16 v[8:11], a[20:23], v[60:63], v[8:11]
    v_mfma_f32_16x16x32_bf16 v[12:15], a[44:47], v[60:63], v[12:15]
    s_waitcnt lgkmcnt(2)
    v_mfma_f32_16x16x32_bf16 v[16:19], a[20:23], v[84:87], v[16:19]
    v_mfma_f32_16x16x32_bf16 v[20:23], a[44:47], v[84:87], v[20:23]
    v_mfma_f32_16x16x32_bf16 v[24:27], a[48:51], a[144:147], 0
    v_mfma_f32_16x16x32_bf16 v[28:31], a[72:75], a[144:147], 0
    v_mfma_f32_16x16x32_bf16 v[32:35], a[48:51], v[64:67], 0
    v_cvt_pk_bf16_f32 v40, v8, v9
    v_cvt_pk_bf16_f32 v41, v10, v11
    v_mfma_f32_16x16x32_bf16 v[36:39], a[72:75], v[64:67], 0
    v_cvt_pk_bf16_f32 v42, v12, v13
    v_cvt_pk_bf16_f32 v43, v14, v15
    v_mfma_f32_16x16x32_bf16 v[24:27], a[52:55], a[148:151], v[24:27]
    ds_write_b128 v5, v[40:43] offset:12288
    v_cvt_pk_bf16_f32 v44, v16, v17
    v_mfma_f32_16x16x32_bf16 v[28:31], a[76:79], a[148:151], v[28:31]
    v_cvt_pk_bf16_f32 v45, v18, v19
    v_cvt_pk_bf16_f32 v46, v20, v21
    v_mfma_f32_16x16x32_bf16 v[32:35], a[52:55], v[68:71], v[32:35]
    v_cvt_pk_bf16_f32 v47, v22, v23
    ds_write_b128 v5, v[44:47] offset:18432
    v_mfma_f32_16x16x32_bf16 v[36:39], a[76:79], v[68:71], v[36:39]
    v_mfma_f32_16x16x32_bf16 v[24:27], a[56:59], a[152:155], v[24:27]
    v_mfma_f32_16x16x32_bf16 v[28:31], a[80:83], a[152:155], v[28:31]
    v_mfma_f32_16x16x32_bf16 v[32:35], a[56:59], v[72:75], v[32:35]
    v_mfma_f32_16x16x32_bf16 v[36:39], a[80:83], v[72:75], v[36:39]
    v_mfma_f32_16x16x32_bf16 v[24:27], a[60:63], a[156:159], v[24:27]
    v_mfma_f32_16x16x32_bf16 v[28:31], a[84:87], a[156:159], v[28:31]
    v_mfma_f32_16x16x32_bf16 v[32:35], a[60:63], v[76:79], v[32:35]
    v_mfma_f32_16x16x32_bf16 v[36:39], a[84:87], v[76:79], v[36:39]
    v_mfma_f32_16x16x32_bf16 v[24:27], a[64:67], v[56:59], v[24:27]
    v_mfma_f32_16x16x32_bf16 v[28:31], a[88:91], v[56:59], v[28:31]
    v_mfma_f32_16x16x32_bf16 v[32:35], a[64:67], v[80:83], v[32:35]
    v_mfma_f32_16x16x32_bf16 v[36:39], a[88:91], v[80:83], v[36:39]
    v_mfma_f32_16x16x32_bf16 v[24:27], a[68:71], v[60:63], v[24:27]
    v_mfma_f32_16x16x32_bf16 v[28:31], a[92:95], v[60:63], v[28:31]
    v_mfma_f32_16x16x32_bf16 v[32:35], a[68:71], v[84:87], v[32:35]
    v_mfma_f32_16x16x32_bf16 v[36:39], a[92:95], v[84:87], v[36:39]
    v_mfma_f32_16x16x32_bf16 v[8:11], a[144:147], a[96:99], 0
    v_mfma_f32_16x16x32_bf16 v[16:19], a[144:147], a[120:123], 0
    v_mfma_f32_16x16x32_bf16 v[12:15], v[64:67], a[96:99], 0
    v_cvt_pk_bf16_f32 v48, v24, v25
    v_cvt_pk_bf16_f32 v49, v26, v27
    v_mfma_f32_16x16x32_bf16 v[20:23], v[64:67], a[120:123], 0
    v_cvt_pk_bf16_f32 v50, v28, v29
    v_cvt_pk_bf16_f32 v51, v30, v31
    v_mfma_f32_16x16x32_bf16 v[8:11], a[148:151], a[100:103], v[8:11]
    ds_write_b128 v5, v[48:51] offset:13312
    v_cvt_pk_bf16_f32 v52, v32, v33
    v_mfma_f32_16x16x32_bf16 v[16:19], a[148:151], a[124:127], v[16:19]
    v_cvt_pk_bf16_f32 v53, v34, v35
    v_cvt_pk_bf16_f32 v54, v36, v37
    v_mfma_f32_16x16x32_bf16 v[12:15], v[68:71], a[100:103], v[12:15]
    v_cvt_pk_bf16_f32 v55, v38, v39
    ds_write_b128 v5, v[52:55] offset:19456
    v_mfma_f32_16x16x32_bf16 v[20:23], v[68:71], a[124:127], v[20:23]
    v_mfma_f32_16x16x32_bf16 v[8:11], a[152:155], a[104:107], v[8:11]
    v_mfma_f32_16x16x32_bf16 v[16:19], a[152:155], a[128:131], v[16:19]
    v_mfma_f32_16x16x32_bf16 v[12:15], v[72:75], a[104:107], v[12:15]
    v_mfma_f32_16x16x32_bf16 v[20:23], v[72:75], a[128:131], v[20:23]
    s_waitcnt lgkmcnt(0)
    s_barrier
L_A_loop01:
    s_mov_b32 s38, s20
    s_add_u32 s20, s20, 24576
    s_cmp_ge_u32 s20, 73728
    s_cselect_b32 s20, 0, s20
    s_sub_u32 s36, s20, s38
    v_add_u32 v1, s36, v1
    v_add_u32 v2, s36, v2
    ds_read_b128 a[144:147], v1 offset:0
    ds_read_b128 v[64:67], v1 offset:6144
    ds_read_b128 a[148:151], v2 offset:0
    ds_read_b128 v[68:71], v2 offset:6144
    ds_read_b128 a[152:155], v1 offset:128
    ds_read_b128 v[72:75], v1 offset:6272
    v_mfma_f32_16x16x32_bf16 v[8:11], a[156:159], a[108:111], v[8:11]
    v_mfma_f32_16x16x32_bf16 v[16:19], a[156:159], a[132:135], v[16:19]
    ds_read_b128 a[156:159], v2 offset:128
    v_mfma_f32_16x16x32_bf16 v[12:15], v[76:79], a[108:111], v[12:15]
    v_mfma_f32_16x16x32_bf16 v[20:23], v[76:79], a[132:135], v[20:23]
    ds_read_b128 v[76:79], v2 offset:6272
    v_mfma_f32_16x16x32_bf16 v[8:11], v[56:59], a[112:115], v[8:11]
    v_mfma_f32_16x16x32_bf16 v[16:19], v[56:59], a[136:139], v[16:19]
    ds_read_b128 v[56:59], v1 offset:256
    v_mfma_f32_16x16x32_bf16 v[12:15], v[80:83], a[112:115], v[12:15]
    v_mfma_f32_16x16x32_bf16 v[20:23], v[80:83], a[136:139], v[20:23]
    ds_read_b128 v[80:83], v1 offset:6400
    v_mfma_f32_16x16x32_bf16 v[8:11], v[60:63], a[116:119], v[8:11]
    v_mfma_f32_16x16x32_bf16 v[16:19], v[60:63], a[140:143], v[16:19]
    ds_read_b128 v[60:63], v2 offset:256
    v_mfma_f32_16x16x32_bf16 v[12:15], v[84:87], a[116:119], v[12:15]
    v_mfma_f32_16x16x32_bf16 v[20:23], v[84:87], a[140:143], v[20:23]
    ds_read_b128 v[84:87], v2 offset:6400
    s_waitcnt lgkmcnt(11)
    v_mfma_f32_16x16x32_bf16 v[24:27], a[0:3], a[144:147], 0
    v_mfma_f32_16x16x32_bf16 v[28:31], a[24:27], a[144:147], 0
    s_waitcnt lgkmcnt(10)
    v_mfma_f32_16x16x32_bf16 v[32:35], a[0:3], v[64:67], 0
    v_cvt_pk_bf16_f32 v40, v8, v9
    v_cvt_pk_bf16_f32 v41, v10, v11
    v_mfma_f32_16x16x32_bf16 v[36:39], a[24:27], v[64:67], 0
    v_cvt_pk_bf16_f32 v42, v12, v13
    v_cvt_pk_bf16_f32 v43, v14, v15
    s_waitcnt lgkmcnt(9)
    v_mfma_f32_16x16x32_bf16 v[24:27], a[4:7], a[148:151], v[24:27]
    ds_write_b128 v6, v[40:43] offset:1024
    v_cvt_pk_bf16_f32 v44, v16, v17
    v_mfma_f32_16x16x32_bf16 v[28:31], a[28:31], a[148:151], v[28:31]
    v_cvt_pk_bf16_f32 v45, v18, v19
    v_cvt_pk_bf16_f32 v46, v20, v21
    s_waitcnt lgkmcnt(9)
    v_mfma_f32_16x16x32_bf16 v[32:35], a[4:7], v[68:71], v[32:35]
    v_cvt_pk_bf16_f32 v47, v22, v23
    ds_write_b128 v6, v[44:47] offset:3072
    v_mfma_f32_16x16x32_bf16 v[36:39], a[28:31], v[68:71], v[36:39]
    s_waitcnt lgkmcnt(9)
    v_mfma_f32_16x16x32_bf16 v[24:27], a[8:11], a[152:155], v[24:27]
    v_mfma_f32_16x16x32_bf16 v[28:31], a[32:35], a[152:155], v[28:31]
    s_waitcnt lgkmcnt(8)
    v_mfma_f32_16x16x32_bf16 v[32:35], a[8:11], v[72:75], v[32:35]
    v_mfma_f32_16x16x32_bf16 v[36:39], a[32:35], v[72:75], v[36:39]
    s_waitcnt lgkmcnt(7)
    v_mfma_f32_16x16x32_bf16 v[24:27], a[12:15], a[156:159], v[24:27]
    s_sub_u32 s21, 0, s21
    v_add_u32 v6, s21, v6
    v_mfma_f32_16x16x32_bf16 v[28:31], a[36:39], a[156:159], v[28:31]
    s_waitcnt lgkmcnt(0)
    s_barrier
    v_mfma_f32_16x16x32_bf16 v[32:35], a[12:15], v[76:79], v[32:35]
    v_mfma_f32_16x16x32_bf16 v[36:39], a[36:39], v[76:79], v[36:39]
    v_mfma_f32_16x16x32_bf16 v[24:27], a[16:19], v[56:59], v[24:27]
    v_mfma_f32_16x16x32_bf16 v[28:31], a[40:43], v[56:59], v[28:31]
    v_mfma_f32_16x16x32_bf16 v[32:35], a[16:19], v[80:83], v[32:35]
    v_mfma_f32_16x16x32_bf16 v[36:39], a[40:43], v[80:83], v[36:39]
    v_mfma_f32_16x16x32_bf16 v[24:27], a[20:23], v[60:63], v[24:27]
    v_mfma_f32_16x16x32_bf16 v[28:31], a[44:47], v[60:63], v[28:31]
    v_mfma_f32_16x16x32_bf16 v[32:35], a[20:23], v[84:87], v[32:35]
    v_mfma_f32_16x16x32_bf16 v[36:39], a[44:47], v[84:87], v[36:39]
    v_mfma_f32_16x16x32_bf16 v[8:11], a[48:51], a[144:147], 0
    v_mfma_f32_16x16x32_bf16 v[12:15], a[72:75], a[144:147], 0
    v_mfma_f32_16x16x32_bf16 v[16:19], a[48:51], v[64:67], 0
    v_cvt_pk_bf16_f32 v48, v24, v25
    v_cvt_pk_bf16_f32 v49, v26, v27
    v_mfma_f32_16x16x32_bf16 v[20:23], a[72:75], v[64:67], 0
    v_cvt_pk_bf16_f32 v50, v28, v29
    v_cvt_pk_bf16_f32 v51, v30, v31
    v_mfma_f32_16x16x32_bf16 v[8:11], a[52:55], a[148:151], v[8:11]
    ds_write_b128 v5, v[48:51] offset:0
    v_cvt_pk_bf16_f32 v52, v32, v33
    v_mfma_f32_16x16x32_bf16 v[12:15], a[76:79], a[148:151], v[12:15]
    v_cvt_pk_bf16_f32 v53, v34, v35
    v_cvt_pk_bf16_f32 v54, v36, v37
    v_mfma_f32_16x16x32_bf16 v[16:19], a[52:55], v[68:71], v[16:19]
    v_cvt_pk_bf16_f32 v55, v38, v39
    ds_write_b128 v5, v[52:55] offset:6144
    v_mfma_f32_16x16x32_bf16 v[20:23], a[76:79], v[68:71], v[20:23]
    v_mfma_f32_16x16x32_bf16 v[8:11], a[56:59], a[152:155], v[8:11]
    v_mfma_f32_16x16x32_bf16 v[12:15], a[80:83], a[152:155], v[12:15]
    v_mfma_f32_16x16x32_bf16 v[16:19], a[56:59], v[72:75], v[16:19]
    v_mfma_f32_16x16x32_bf16 v[20:23], a[80:83], v[72:75], v[20:23]
    v_mfma_f32_16x16x32_bf16 v[8:11], a[60:63], a[156:159], v[8:11]
    v_mfma_f32_16x16x32_bf16 v[12:15], a[84:87], a[156:159], v[12:15]
    v_mfma_f32_16x16x32_bf16 v[16:19], a[60:63], v[76:79], v[16:19]
    v_mfma_f32_16x16x32_bf16 v[20:23], a[84:87], v[76:79], v[20:23]
    v_mfma_f32_16x16x32_bf16 v[8:11], a[64:67], v[56:59], v[8:11]
    v_mfma_f32_16x16x32_bf16 v[12:15], a[88:91], v[56:59], v[12:15]
    v_mfma_f32_16x16x32_bf16 v[16:19], a[64:67], v[80:83], v[16:19]
    v_mfma_f32_16x16x32_bf16 v[20:23], a[88:91], v[80:83], v[20:23]
    v_mfma_f32_16x16x32_bf16 v[8:11], a[68:71], v[60:63], v[8:11]
    v_mfma_f32_16x16x32_bf16 v[12:15], a[92:95], v[60:63], v[12:15]
    v_mfma_f32_16x16x32_bf16 v[16:19], a[68:71], v[84:87], v[16:19]
    v_mfma_f32_16x16x32_bf16 v[20:23], a[92:95], v[84:87], v[20:23]
    v_mfma_f32_16x16x32_bf16 v[24:27], a[144:147], a[96:99], 0
    v_mfma_f32_16x16x32_bf16 v[32:35], a[144:147], a[120:123], 0
    ds_read_b128 a[144:147], v1 offset:12288
    v_mfma_f32_16x16x32_bf16 v[28:31], v[64:67], a[96:99], 0
    v_cvt_pk_bf16_f32 v40, v8, v9
    v_cvt_pk_bf16_f32 v41, v10, v11
    v_mfma_f32_16x16x32_bf16 v[36:39], v[64:67], a[120:123], 0
    ds_read_b128 v[64:67], v1 offset:18432
    v_cvt_pk_bf16_f32 v42, v12, v13
    v_mfma_f32_16x16x32_bf16 v[24:27], a[148:151], a[100:103], v[24:27]
    v_cvt_pk_bf16_f32 v43, v14, v15
    ds_write_b128 v5, v[40:43] offset:1024
    v_mfma_f32_16x16x32_bf16 v[32:35], a[148:151], a[124:127], v[32:35]
    ds_read_b128 a[148:151], v2 offset:12288
    v_cvt_pk_bf16_f32 v44, v16, v17
    v_mfma_f32_16x16x32_bf16 v[28:31], v[68:71], a[100:103], v[28:31]
    v_cvt_pk_bf16_f32 v45, v18, v19
    v_cvt_pk_bf16_f32 v46, v20, v21
    v_mfma_f32_16x16x32_bf16 v[36:39], v[68:71], a[124:127], v[36:39]
    ds_read_b128 v[68:71], v2 offset:18432
    v_cvt_pk_bf16_f32 v47, v22, v23
    v_mfma_f32_16x16x32_bf16 v[24:27], a[152:155], a[104:107], v[24:27]
    ds_write_b128 v5, v[44:47] offset:7168
    v_mfma_f32_16x16x32_bf16 v[32:35], a[152:155], a[128:131], v[32:35]
    ds_read_b128 a[152:155], v1 offset:12416
    v_mfma_f32_16x16x32_bf16 v[28:31], v[72:75], a[104:107], v[28:31]
    v_mfma_f32_16x16x32_bf16 v[36:39], v[72:75], a[128:131], v[36:39]
    ds_read_b128 v[72:75], v1 offset:18560
    v_mfma_f32_16x16x32_bf16 v[24:27], a[156:159], a[108:111], v[24:27]
    v_mfma_f32_16x16x32_bf16 v[32:35], a[156:159], a[132:135], v[32:35]
    ds_read_b128 a[156:159], v2 offset:12416
    v_mfma_f32_16x16x32_bf16 v[28:31], v[76:79], a[108:111], v[28:31]
    v_mfma_f32_16x16x32_bf16 v[36:39], v[76:79], a[132:135], v[36:39]
    ds_read_b128 v[76:79], v2 offset:18560
    v_mfma_f32_16x16x32_bf16 v[24:27], v[56:59], a[112:115], v[24:27]
    v_mfma_f32_16x16x32_bf16 v[32:35], v[56:59], a[136:139], v[32:35]
    ds_read_b128 v[56:59], v1 offset:12544
    v_mfma_f32_16x16x32_bf16 v[28:31], v[80:83], a[112:115], v[28:31]
    v_mfma_f32_16x16x32_bf16 v[36:39], v[80:83], a[136:139], v[36:39]
    ds_read_b128 v[80:83], v1 offset:18688
    v_mfma_f32_16x16x32_bf16 v[24:27], v[60:63], a[116:119], v[24:27]
    v_mfma_f32_16x16x32_bf16 v[32:35], v[60:63], a[140:143], v[32:35]
    ds_read_b128 v[60:63], v2 offset:12544
    v_mfma_f32_16x16x32_bf16 v[28:31], v[84:87], a[116:119], v[28:31]
    v_mfma_f32_16x16x32_bf16 v[36:39], v[84:87], a[140:143], v[36:39]
    ds_read_b128 v[84:87], v2 offset:18688
    s_waitcnt lgkmcnt(13)
    v_mfma_f32_16x16x32_bf16 v[8:11], a[0:3], a[144:147], 0
    v_mfma_f32_16x16x32_bf16 v[12:15], a[24:27], a[144:147], 0
    s_waitcnt lgkmcnt(12)
    v_mfma_f32_16x16x32_bf16 v[16:19], a[0:3], v[64:67], 0
    v_cvt_pk_bf16_f32 v48, v24, v25
    v_cvt_pk_bf16_f32 v49, v26, v27
    v_mfma_f32_16x16x32_bf16 v[20:23], a[24:27], v[64:67], 0
    v_cvt_pk_bf16_f32 v50, v28, v29
    v_cvt_pk_bf16_f32 v51, v30, v31
    s_waitcnt lgkmcnt(10)
    v_mfma_f32_16x16x32_bf16 v[8:11], a[4:7], a[148:151], v[8:11]
    ds_write_b128 v6, v[48:51] offset:0
    v_cvt_pk_bf16_f32 v52, v32, v33
    v_mfma_f32_16x16x32_bf16 v[12:15], a[28:31], a[148:151], v[12:15]
    v_cvt_pk_bf16_f32 v53, v34, v35
    v_cvt_pk_bf16_f32 v54, v36, v37
    s_waitcnt lgkmcnt(10)
    v_mfma_f32_16x16x32_bf16 v[16:19], a[4:7], v[68:71], v[16:19]
    v_cvt_pk_bf16_f32 v55, v38, v39
    ds_write_b128 v6, v[52:55] offset:2048
    v_mfma_f32_16x16x32_bf16 v[20:23], a[28:31], v[68:71], v[20:23]
    s_waitcnt lgkmcnt(9)
    v_mfma_f32_16x16x32_bf16 v[8:11], a[8:11], a[152:155], v[8:11]
    v_mfma_f32_16x16x32_bf16 v[12:15], a[32:35], a[152:155], v[12:15]
    s_waitcnt lgkmcnt(8)
    v_mfma_f32_16x16x32_bf16 v[16:19], a[8:11], v[72:75], v[16:19]
    v_mfma_f32_16x16x32_bf16 v[20:23], a[32:35], v[72:75], v[20:23]
    s_waitcnt lgkmcnt(7)
    v_mfma_f32_16x16x32_bf16 v[8:11], a[12:15], a[156:159], v[8:11]
    v_mfma_f32_16x16x32_bf16 v[12:15], a[36:39], a[156:159], v[12:15]
    s_waitcnt lgkmcnt(6)
    v_mfma_f32_16x16x32_bf16 v[16:19], a[12:15], v[76:79], v[16:19]
    v_mfma_f32_16x16x32_bf16 v[20:23], a[36:39], v[76:79], v[20:23]
    s_waitcnt lgkmcnt(5)
    v_mfma_f32_16x16x32_bf16 v[8:11], a[16:19], v[56:59], v[8:11]
    v_mfma_f32_16x16x32_bf16 v[12:15], a[40:43], v[56:59], v[12:15]
    s_waitcnt lgkmcnt(4)
    v_mfma_f32_16x16x32_bf16 v[16:19], a[16:19], v[80:83], v[16:19]
    v_mfma_f32_16x16x32_bf16 v[20:23], a[40:43], v[80:83], v[20:23]
    s_waitcnt lgkmcnt(3)
    v_mfma_f32_16x16x32_bf16 v[8:11], a[20:23], v[60:63], v[8:11]
    v_mfma_f32_16x16x32_bf16 v[12:15], a[44:47], v[60:63], v[12:15]
    s_waitcnt lgkmcnt(2)
    v_mfma_f32_16x16x32_bf16 v[16:19], a[20:23], v[84:87], v[16:19]
    v_mfma_f32_16x16x32_bf16 v[20:23], a[44:47], v[84:87], v[20:23]
    v_mfma_f32_16x16x32_bf16 v[24:27], a[48:51], a[144:147], 0
    v_mfma_f32_16x16x32_bf16 v[28:31], a[72:75], a[144:147], 0
    v_mfma_f32_16x16x32_bf16 v[32:35], a[48:51], v[64:67], 0
    v_cvt_pk_bf16_f32 v40, v8, v9
    v_cvt_pk_bf16_f32 v41, v10, v11
    v_mfma_f32_16x16x32_bf16 v[36:39], a[72:75], v[64:67], 0
    v_cvt_pk_bf16_f32 v42, v12, v13
    v_cvt_pk_bf16_f32 v43, v14, v15
    v_mfma_f32_16x16x32_bf16 v[24:27], a[52:55], a[148:151], v[24:27]
    ds_write_b128 v5, v[40:43] offset:12288
    v_cvt_pk_bf16_f32 v44, v16, v17
    v_mfma_f32_16x16x32_bf16 v[28:31], a[76:79], a[148:151], v[28:31]
    v_cvt_pk_bf16_f32 v45, v18, v19
    v_cvt_pk_bf16_f32 v46, v20, v21
    v_mfma_f32_16x16x32_bf16 v[32:35], a[52:55], v[68:71], v[32:35]
    v_cvt_pk_bf16_f32 v47, v22, v23
    ds_write_b128 v5, v[44:47] offset:18432
    v_mfma_f32_16x16x32_bf16 v[36:39], a[76:79], v[68:71], v[36:39]
    v_mfma_f32_16x16x32_bf16 v[24:27], a[56:59], a[152:155], v[24:27]
    v_mfma_f32_16x16x32_bf16 v[28:31], a[80:83], a[152:155], v[28:31]
    v_mfma_f32_16x16x32_bf16 v[32:35], a[56:59], v[72:75], v[32:35]
    v_mfma_f32_16x16x32_bf16 v[36:39], a[80:83], v[72:75], v[36:39]
    v_mfma_f32_16x16x32_bf16 v[24:27], a[60:63], a[156:159], v[24:27]
    v_mfma_f32_16x16x32_bf16 v[28:31], a[84:87], a[156:159], v[28:31]
    v_mfma_f32_16x16x32_bf16 v[32:35], a[60:63], v[76:79], v[32:35]
    v_mfma_f32_16x16x32_bf16 v[36:39], a[84:87], v[76:79], v[36:39]
    v_mfma_f32_16x16x32_bf16 v[24:27], a[64:67], v[56:59], v[24:27]
    v_mfma_f32_16x16x32_bf16 v[28:31], a[88:91], v[56:59], v[28:31]
    v_mfma_f32_16x16x32_bf16 v[32:35], a[64:67], v[80:83], v[32:35]
    v_mfma_f32_16x16x32_bf16 v[36:39], a[88:91], v[80:83], v[36:39]
    v_mfma_f32_16x16x32_bf16 v[24:27], a[68:71], v[60:63], v[24:27]
    v_mfma_f32_16x16x32_bf16 v[28:31], a[92:95], v[60:63], v[28:31]
    v_mfma_f32_16x16x32_bf16 v[32:35], a[68:71], v[84:87], v[32:35]
    v_mfma_f32_16x16x32_bf16 v[36:39], a[92:95], v[84:87], v[36:39]
    v_mfma_f32_16x16x32_bf16 v[8:11], a[144:147], a[96:99], 0
    v_mfma_f32_16x16x32_bf16 v[16:19], a[144:147], a[120:123], 0
    v_mfma_f32_16x16x32_bf16 v[12:15], v[64:67], a[96:99], 0
    v_cvt_pk_bf16_f32 v48, v24, v25
    v_cvt_pk_bf16_f32 v49, v26, v27
    v_mfma_f32_16x16x32_bf16 v[20:23], v[64:67], a[120:123], 0
    v_cvt_pk_bf16_f32 v50, v28, v29
    v_cvt_pk_bf16_f32 v51, v30, v31
    v_mfma_f32_16x16x32_bf16 v[8:11], a[148:151], a[100:103], v[8:11]
    ds_write_b128 v5, v[48:51] offset:13312
    v_cvt_pk_bf16_f32 v52, v32, v33
    v_mfma_f32_16x16x32_bf16 v[16:19], a[148:151], a[124:127], v[16:19]
    v_cvt_pk_bf16_f32 v53, v34, v35
    v_cvt_pk_bf16_f32 v54, v36, v37
    v_mfma_f32_16x16x32_bf16 v[12:15], v[68:71], a[100:103], v[12:15]
    v_cvt_pk_bf16_f32 v55, v38, v39
    ds_write_b128 v5, v[52:55] offset:19456
    v_mfma_f32_16x16x32_bf16 v[20:23], v[68:71], a[124:127], v[20:23]
    v_mfma_f32_16x16x32_bf16 v[8:11], a[152:155], a[104:107], v[8:11]
    v_mfma_f32_16x16x32_bf16 v[16:19], a[152:155], a[128:131], v[16:19]
    v_mfma_f32_16x16x32_bf16 v[12:15], v[72:75], a[104:107], v[12:15]
    v_mfma_f32_16x16x32_bf16 v[20:23], v[72:75], a[128:131], v[20:23]
    s_add_u32 s17, s17, 1
    s_waitcnt lgkmcnt(0)
    s_barrier
    s_cmp_lt_u32 s17, 8
    s_cbranch_scc1 L_A_loop01
    v_mfma_f32_16x16x32_bf16 v[8:11], a[156:159], a[108:111], v[8:11]
    v_mfma_f32_16x16x32_bf16 v[16:19], a[156:159], a[132:135], v[16:19]
    v_mfma_f32_16x16x32_bf16 v[12:15], v[76:79], a[108:111], v[12:15]
    v_mfma_f32_16x16x32_bf16 v[20:23], v[76:79], a[132:135], v[20:23]
    v_mfma_f32_16x16x32_bf16 v[8:11], v[56:59], a[112:115], v[8:11]
    v_mfma_f32_16x16x32_bf16 v[16:19], v[56:59], a[136:139], v[16:19]
    v_mfma_f32_16x16x32_bf16 v[12:15], v[80:83], a[112:115], v[12:15]
    v_mfma_f32_16x16x32_bf16 v[20:23], v[80:83], a[136:139], v[20:23]
    v_mfma_f32_16x16x32_bf16 v[8:11], v[60:63], a[116:119], v[8:11]
    v_mfma_f32_16x16x32_bf16 v[16:19], v[60:63], a[140:143], v[16:19]
    v_mfma_f32_16x16x32_bf16 v[12:15], v[84:87], a[116:119], v[12:15]
    v_mfma_f32_16x16x32_bf16 v[20:23], v[84:87], a[140:143], v[20:23]
    v_cvt_pk_bf16_f32 v40, v8, v9
    v_cvt_pk_bf16_f32 v41, v10, v11
    s_nop 1
    v_cvt_pk_bf16_f32 v42, v12, v13
    v_cvt_pk_bf16_f32 v43, v14, v15
    ds_write_b128 v6, v[40:43] offset:1024
    v_cvt_pk_bf16_f32 v44, v16, v17
    v_cvt_pk_bf16_f32 v45, v18, v19
    v_cvt_pk_bf16_f32 v46, v20, v21
    v_cvt_pk_bf16_f32 v47, v22, v23
    ds_write_b128 v6, v[44:47] offset:3072
    s_waitcnt lgkmcnt(0)
    s_barrier
    s_endpgm
L_A_23:
    s_setprio 1
    buffer_load_dwordx4 a[0:3], v3, s[12:15], s60 offen offset:0
    buffer_load_dwordx4 a[24:27], v3, s[12:15], s61 offen offset:2048
    buffer_load_dwordx4 a[4:7], v3, s[12:15], s60 offen offset:1024
    buffer_load_dwordx4 a[28:31], v3, s[12:15], s61 offen offset:3072
    buffer_load_dwordx4 a[8:11], v3, s[12:15], s60 offen offset:2048
    buffer_load_dwordx4 a[32:35], v3, s[12:15], s62 offen offset:0
    buffer_load_dwordx4 a[12:15], v3, s[12:15], s60 offen offset:3072
    buffer_load_dwordx4 a[36:39], v3, s[12:15], s62 offen offset:1024
    buffer_load_dwordx4 a[16:19], v3, s[12:15], s61 offen offset:0
    buffer_load_dwordx4 a[40:43], v3, s[12:15], s62 offen offset:2048
    buffer_load_dwordx4 a[20:23], v3, s[12:15], s61 offen offset:1024
    buffer_load_dwordx4 a[44:47], v3, s[12:15], s62 offen offset:3072
    buffer_load_dwordx4 a[48:51], v3, s[12:15], s63 offen offset:0
    buffer_load_dwordx4 a[72:75], v3, s[12:15], s64 offen offset:2048
    buffer_load_dwordx4 a[52:55], v3, s[12:15], s63 offen offset:1024
    buffer_load_dwordx4 a[76:79], v3, s[12:15], s64 offen offset:3072
    buffer_load_dwordx4 a[56:59], v3, s[12:15], s63 offen offset:2048
    buffer_load_dwordx4 a[80:83], v3, s[12:15], s65 offen offset:0
    buffer_load_dwordx4 a[60:63], v3, s[12:15], s63 offen offset:3072
    buffer_load_dwordx4 a[84:87], v3, s[12:15], s65 offen offset:1024
    buffer_load_dwordx4 a[64:67], v3, s[12:15], s64 offen offset:0
    buffer_load_dwordx4 a[88:91], v3, s[12:15], s65 offen offset:2048
    buffer_load_dwordx4 a[68:71], v3, s[12:15], s64 offen offset:1024
    buffer_load_dwordx4 a[92:95], v3, s[12:15], s65 offen offset:3072
    buffer_load_dwordx4 a[96:99], v3, s[12:15], s66 offen offset:0
    buffer_load_dwordx4 a[120:123], v3, s[12:15], s67 offen offset:2048
    buffer_load_dwordx4 a[100:103], v3, s[12:15], s66 offen offset:1024
    buffer_load_dwordx4 a[124:127], v3, s[12:15], s67 offen offset:3072
    buffer_load_dwordx4 a[104:107], v3, s[12:15], s66 offen offset:2048
    buffer_load_dwordx4 a[128:131], v3, s[12:15], s68 offen offset:0
    buffer_load_dwordx4 a[108:111], v3, s[12:15], s66 offen offset:3072
    buffer_load_dwordx4 a[132:135], v3, s[12:15], s68 offen offset:1024
    buffer_load_dwordx4 a[112:115], v3, s[12:15], s67 offen offset:0
    buffer_load_dwordx4 a[136:139], v3, s[12:15], s68 offen offset:2048
    buffer_load_dwordx4 a[116:119], v3, s[12:15], s67 offen offset:1024
    buffer_load_dwordx4 a[140:143], v3, s[12:15], s68 offen offset:3072
    s_barrier
    ds_read_b128 a[144:147], v1 offset:0
    ds_read_b128 a[148:151], v2 offset:0
    ds_read_b128 a[152:155], v1 offset:128
    ds_read_b128 a[156:159], v2 offset:128
    ds_read_b128 v[56:59], v1 offset:256
    ds_read_b128 v[60:63], v2 offset:256
    ds_read_b128 v[64:67], v1 offset:6144
    ds_read_b128 v[68:71], v2 offset:6144
    ds_read_b128 v[72:75], v1 offset:6272
    ds_read_b128 v[76:79], v2 offset:6272
    ds_read_b128 v[80:83], v1 offset:6400
    ds_read_b128 v[84:87], v2 offset:6400
    s_waitcnt vmcnt(35) lgkmcnt(11)
    v_mfma_f32_16x16x32_bf16 v[24:27], a[0:3], a[144:147], 0
    s_waitcnt vmcnt(34)
    v_mfma_f32_16x16x32_bf16 v[28:31], a[24:27], a[144:147], 0
    s_waitcnt lgkmcnt(5)
    v_mfma_f32_16x16x32_bf16 v[32:35], a[0:3], v[64:67], 0
    v_mfma_f32_16x16x32_bf16 v[36:39], a[24:27], v[64:67], 0
    s_waitcnt vmcnt(33)
    v_mfma_f32_16x16x32_bf16 v[24:27], a[4:7], a[148:151], v[24:27]
    s_waitcnt vmcnt(32)
    v_mfma_f32_16x16x32_bf16 v[28:31], a[28:31], a[148:151], v[28:31]
    s_waitcnt lgkmcnt(4)
    v_mfma_f32_16x16x32_bf16 v[32:35], a[4:7], v[68:71], v[32:35]
    v_mfma_f32_16x16x32_bf16 v[36:39], a[28:31], v[68:71], v[36:39]
    s_waitcnt vmcnt(31)
    v_mfma_f32_16x16x32_bf16 v[24:27], a[8:11], a[152:155], v[24:27]
    s_waitcnt vmcnt(30)
    v_mfma_f32_16x16x32_bf16 v[28:31], a[32:35], a[152:155], v[28:31]
    s_waitcnt lgkmcnt(3)
    v_mfma_f32_16x16x32_bf16 v[32:35], a[8:11], v[72:75], v[32:35]
    v_mfma_f32_16x16x32_bf16 v[36:39], a[32:35], v[72:75], v[36:39]
    s_waitcnt vmcnt(29)
    v_mfma_f32_16x16x32_bf16 v[24:27], a[12:15], a[156:159], v[24:27]
    s_waitcnt vmcnt(28)
    v_mfma_f32_16x16x32_bf16 v[28:31], a[36:39], a[156:159], v[28:31]
    s_waitcnt lgkmcnt(2)
    v_mfma_f32_16x16x32_bf16 v[32:35], a[12:15], v[76:79], v[32:35]
    v_mfma_f32_16x16x32_bf16 v[36:39], a[36:39], v[76:79], v[36:39]
    s_waitcnt vmcnt(27)
    v_mfma_f32_16x16x32_bf16 v[24:27], a[16:19], v[56:59], v[24:27]
    s_waitcnt vmcnt(26)
    v_mfma_f32_16x16x32_bf16 v[28:31], a[40:43], v[56:59], v[28:31]
    s_waitcnt lgkmcnt(1)
    v_mfma_f32_16x16x32_bf16 v[32:35], a[16:19], v[80:83], v[32:35]
    v_mfma_f32_16x16x32_bf16 v[36:39], a[40:43], v[80:83], v[36:39]
    s_waitcnt vmcnt(25)
    v_mfma_f32_16x16x32_bf16 v[24:27], a[20:23], v[60:63], v[24:27]
    s_waitcnt vmcnt(24)
    v_mfma_f32_16x16x32_bf16 v[28:31], a[44:47], v[60:63], v[28:31]
    s_waitcnt lgkmcnt(0)
    v_mfma_f32_16x16x32_bf16 v[32:35], a[20:23], v[84:87], v[32:35]
    v_mfma_f32_16x16x32_bf16 v[36:39], a[44:47], v[84:87], v[36:39]
    s_waitcnt vmcnt(23)
    v_mfma_f32_16x16x32_bf16 v[8:11], a[144:147], a[48:51], 0
    s_waitcnt vmcnt(22)
    v_mfma_f32_16x16x32_bf16 v[16:19], a[144:147], a[72:75], 0
    v_mfma_f32_16x16x32_bf16 v[12:15], v[64:67], a[48:51], 0
    v_cvt_pk_bf16_f32 v48, v24, v25
    v_cvt_pk_bf16_f32 v49, v26, v27
    v_mfma_f32_16x16x32_bf16 v[20:23], v[64:67], a[72:75], 0
    v_cvt_pk_bf16_f32 v50, v28, v29
    v_cvt_pk_bf16_f32 v51, v30, v31
    s_waitcnt vmcnt(21)
    v_mfma_f32_16x16x32_bf16 v[8:11], a[148:151], a[52:55], v[8:11]
    ds_write_b128 v5, v[48:51] offset:0
    v_cvt_pk_bf16_f32 v52, v32, v33
    s_waitcnt vmcnt(20)
    v_mfma_f32_16x16x32_bf16 v[16:19], a[148:151], a[76:79], v[16:19]
    v_cvt_pk_bf16_f32 v53, v34, v35
    v_cvt_pk_bf16_f32 v54, v36, v37
    v_mfma_f32_16x16x32_bf16 v[12:15], v[68:71], a[52:55], v[12:15]
    v_cvt_pk_bf16_f32 v55, v38, v39
    ds_write_b128 v5, v[52:55] offset:6144
    v_mfma_f32_16x16x32_bf16 v[20:23], v[68:71], a[76:79], v[20:23]
    s_waitcnt vmcnt(19)
    v_mfma_f32_16x16x32_bf16 v[8:11], a[152:155], a[56:59], v[8:11]
    s_waitcnt vmcnt(18)
    v_mfma_f32_16x16x32_bf16 v[16:19], a[152:155], a[80:83], v[16:19]
    v_mfma_f32_16x16x32_bf16 v[12:15], v[72:75], a[56:59], v[12:15]
    v_mfma_f32_16x16x32_bf16 v[20:23], v[72:75], a[80:83], v[20:23]
    s_waitcnt vmcnt(17)
    v_mfma_f32_16x16x32_bf16 v[8:11], a[156:159], a[60:63], v[8:11]
    s_waitcnt vmcnt(16)
    v_mfma_f32_16x16x32_bf16 v[16:19], a[156:159], a[84:87], v[16:19]
    v_mfma_f32_16x16x32_bf16 v[12:15], v[76:79], a[60:63], v[12:15]
    v_mfma_f32_16x16x32_bf16 v[20:23], v[76:79], a[84:87], v[20:23]
    s_waitcnt vmcnt(15)
    v_mfma_f32_16x16x32_bf16 v[8:11], v[56:59], a[64:67], v[8:11]
    s_waitcnt vmcnt(14)
    v_mfma_f32_16x16x32_bf16 v[16:19], v[56:59], a[88:91], v[16:19]
    v_mfma_f32_16x16x32_bf16 v[12:15], v[80:83], a[64:67], v[12:15]
    v_mfma_f32_16x16x32_bf16 v[20:23], v[80:83], a[88:91], v[20:23]
    s_waitcnt vmcnt(13)
    v_mfma_f32_16x16x32_bf16 v[8:11], v[60:63], a[68:71], v[8:11]
    s_waitcnt vmcnt(12)
    v_mfma_f32_16x16x32_bf16 v[16:19], v[60:63], a[92:95], v[16:19]
    v_mfma_f32_16x16x32_bf16 v[12:15], v[84:87], a[68:71], v[12:15]
    v_mfma_f32_16x16x32_bf16 v[20:23], v[84:87], a[92:95], v[20:23]
    s_waitcnt vmcnt(11)
    v_mfma_f32_16x16x32_bf16 v[24:27], a[144:147], a[96:99], 0
    s_waitcnt vmcnt(10)
    v_mfma_f32_16x16x32_bf16 v[32:35], a[144:147], a[120:123], 0
    ds_read_b128 a[144:147], v1 offset:12288
    v_mfma_f32_16x16x32_bf16 v[28:31], v[64:67], a[96:99], 0
    v_cvt_pk_bf16_f32 v40, v8, v9
    v_cvt_pk_bf16_f32 v41, v10, v11
    v_mfma_f32_16x16x32_bf16 v[36:39], v[64:67], a[120:123], 0
    ds_read_b128 v[64:67], v1 offset:18432
    v_cvt_pk_bf16_f32 v42, v12, v13
    s_waitcnt vmcnt(9)
    v_mfma_f32_16x16x32_bf16 v[24:27], a[148:151], a[100:103], v[24:27]
    v_cvt_pk_bf16_f32 v43, v14, v15
    ds_write_b128 v6, v[40:43] offset:0
    s_waitcnt vmcnt(8)
    v_mfma_f32_16x16x32_bf16 v[32:35], a[148:151], a[124:127], v[32:35]
    ds_read_b128 a[148:151], v2 offset:12288
    v_cvt_pk_bf16_f32 v44, v16, v17
    v_mfma_f32_16x16x32_bf16 v[28:31], v[68:71], a[100:103], v[28:31]
    v_cvt_pk_bf16_f32 v45, v18, v19
    v_cvt_pk_bf16_f32 v46, v20, v21
    v_mfma_f32_16x16x32_bf16 v[36:39], v[68:71], a[124:127], v[36:39]
    ds_read_b128 v[68:71], v2 offset:18432
    v_cvt_pk_bf16_f32 v47, v22, v23
    s_waitcnt vmcnt(7)
    v_mfma_f32_16x16x32_bf16 v[24:27], a[152:155], a[104:107], v[24:27]
    ds_write_b128 v6, v[44:47] offset:2048
    s_waitcnt vmcnt(6)
    v_mfma_f32_16x16x32_bf16 v[32:35], a[152:155], a[128:131], v[32:35]
    ds_read_b128 a[152:155], v1 offset:12416
    v_mfma_f32_16x16x32_bf16 v[28:31], v[72:75], a[104:107], v[28:31]
    v_mfma_f32_16x16x32_bf16 v[36:39], v[72:75], a[128:131], v[36:39]
    ds_read_b128 v[72:75], v1 offset:18560
    s_waitcnt vmcnt(5)
    v_mfma_f32_16x16x32_bf16 v[24:27], a[156:159], a[108:111], v[24:27]
    s_waitcnt vmcnt(4)
    v_mfma_f32_16x16x32_bf16 v[32:35], a[156:159], a[132:135], v[32:35]
    ds_read_b128 a[156:159], v2 offset:12416
    v_mfma_f32_16x16x32_bf16 v[28:31], v[76:79], a[108:111], v[28:31]
    v_mfma_f32_16x16x32_bf16 v[36:39], v[76:79], a[132:135], v[36:39]
    ds_read_b128 v[76:79], v2 offset:18560
    s_waitcnt vmcnt(3)
    v_mfma_f32_16x16x32_bf16 v[24:27], v[56:59], a[112:115], v[24:27]
    s_waitcnt vmcnt(2)
    v_mfma_f32_16x16x32_bf16 v[32:35], v[56:59], a[136:139], v[32:35]
    ds_read_b128 v[56:59], v1 offset:12544
    v_mfma_f32_16x16x32_bf16 v[28:31], v[80:83], a[112:115], v[28:31]
    v_mfma_f32_16x16x32_bf16 v[36:39], v[80:83], a[136:139], v[36:39]
    ds_read_b128 v[80:83], v1 offset:18688
    s_waitcnt vmcnt(1)
    v_mfma_f32_16x16x32_bf16 v[24:27], v[60:63], a[116:119], v[24:27]
    s_waitcnt vmcnt(0)
    v_mfma_f32_16x16x32_bf16 v[32:35], v[60:63], a[140:143], v[32:35]
    ds_read_b128 v[60:63], v2 offset:12544
    v_mfma_f32_16x16x32_bf16 v[28:31], v[84:87], a[116:119], v[28:31]
    v_mfma_f32_16x16x32_bf16 v[36:39], v[84:87], a[140:143], v[36:39]
    ds_read_b128 v[84:87], v2 offset:18688
    s_waitcnt lgkmcnt(13)
    v_mfma_f32_16x16x32_bf16 v[8:11], a[0:3], a[144:147], 0
    v_mfma_f32_16x16x32_bf16 v[12:15], a[24:27], a[144:147], 0
    s_waitcnt lgkmcnt(12)
    v_mfma_f32_16x16x32_bf16 v[16:19], a[0:3], v[64:67], 0
    v_cvt_pk_bf16_f32 v48, v24, v25
    v_cvt_pk_bf16_f32 v49, v26, v27
    v_mfma_f32_16x16x32_bf16 v[20:23], a[24:27], v[64:67], 0
    v_cvt_pk_bf16_f32 v50, v28, v29
    v_cvt_pk_bf16_f32 v51, v30, v31
    s_waitcnt lgkmcnt(10)
    v_mfma_f32_16x16x32_bf16 v[8:11], a[4:7], a[148:151], v[8:11]
    ds_write_b128 v6, v[48:51] offset:4096
    v_cvt_pk_bf16_f32 v52, v32, v33
    v_mfma_f32_16x16x32_bf16 v[12:15], a[28:31], a[148:151], v[12:15]
    v_cvt_pk_bf16_f32 v53, v34, v35
    v_cvt_pk_bf16_f32 v54, v36, v37
    s_waitcnt lgkmcnt(10)
    v_mfma_f32_16x16x32_bf16 v[16:19], a[4:7], v[68:71], v[16:19]
    v_cvt_pk_bf16_f32 v55, v38, v39
    ds_write_b128 v6, v[52:55] offset:6144
    v_mfma_f32_16x16x32_bf16 v[20:23], a[28:31], v[68:71], v[20:23]
    s_waitcnt lgkmcnt(9)
    v_mfma_f32_16x16x32_bf16 v[8:11], a[8:11], a[152:155], v[8:11]
    v_mfma_f32_16x16x32_bf16 v[12:15], a[32:35], a[152:155], v[12:15]
    s_waitcnt lgkmcnt(8)
    v_mfma_f32_16x16x32_bf16 v[16:19], a[8:11], v[72:75], v[16:19]
    v_mfma_f32_16x16x32_bf16 v[20:23], a[32:35], v[72:75], v[20:23]
    s_waitcnt lgkmcnt(7)
    v_mfma_f32_16x16x32_bf16 v[8:11], a[12:15], a[156:159], v[8:11]
    v_mfma_f32_16x16x32_bf16 v[12:15], a[36:39], a[156:159], v[12:15]
    s_waitcnt lgkmcnt(6)
    v_mfma_f32_16x16x32_bf16 v[16:19], a[12:15], v[76:79], v[16:19]
    v_mfma_f32_16x16x32_bf16 v[20:23], a[36:39], v[76:79], v[20:23]
    s_waitcnt lgkmcnt(5)
    v_mfma_f32_16x16x32_bf16 v[8:11], a[16:19], v[56:59], v[8:11]
    v_mfma_f32_16x16x32_bf16 v[12:15], a[40:43], v[56:59], v[12:15]
    s_waitcnt lgkmcnt(4)
    v_mfma_f32_16x16x32_bf16 v[16:19], a[16:19], v[80:83], v[16:19]
    v_mfma_f32_16x16x32_bf16 v[20:23], a[40:43], v[80:83], v[20:23]
    s_waitcnt lgkmcnt(3)
    v_mfma_f32_16x16x32_bf16 v[8:11], a[20:23], v[60:63], v[8:11]
    v_mfma_f32_16x16x32_bf16 v[12:15], a[44:47], v[60:63], v[12:15]
    s_waitcnt lgkmcnt(2)
    v_mfma_f32_16x16x32_bf16 v[16:19], a[20:23], v[84:87], v[16:19]
    v_mfma_f32_16x16x32_bf16 v[20:23], a[44:47], v[84:87], v[20:23]
    v_mfma_f32_16x16x32_bf16 v[24:27], a[144:147], a[48:51], 0
    v_mfma_f32_16x16x32_bf16 v[32:35], a[144:147], a[72:75], 0
    v_mfma_f32_16x16x32_bf16 v[28:31], v[64:67], a[48:51], 0
    v_cvt_pk_bf16_f32 v40, v8, v9
    v_cvt_pk_bf16_f32 v41, v10, v11
    v_mfma_f32_16x16x32_bf16 v[36:39], v[64:67], a[72:75], 0
    v_cvt_pk_bf16_f32 v42, v12, v13
    v_cvt_pk_bf16_f32 v43, v14, v15
    v_mfma_f32_16x16x32_bf16 v[24:27], a[148:151], a[52:55], v[24:27]
    ds_write_b128 v5, v[40:43] offset:12288
    v_cvt_pk_bf16_f32 v44, v16, v17
    v_mfma_f32_16x16x32_bf16 v[32:35], a[148:151], a[76:79], v[32:35]
    v_cvt_pk_bf16_f32 v45, v18, v19
    v_cvt_pk_bf16_f32 v46, v20, v21
    v_mfma_f32_16x16x32_bf16 v[28:31], v[68:71], a[52:55], v[28:31]
    v_cvt_pk_bf16_f32 v47, v22, v23
    ds_write_b128 v5, v[44:47] offset:18432
    v_mfma_f32_16x16x32_bf16 v[36:39], v[68:71], a[76:79], v[36:39]
    v_mfma_f32_16x16x32_bf16 v[24:27], a[152:155], a[56:59], v[24:27]
    v_mfma_f32_16x16x32_bf16 v[32:35], a[152:155], a[80:83], v[32:35]
    v_mfma_f32_16x16x32_bf16 v[28:31], v[72:75], a[56:59], v[28:31]
    v_mfma_f32_16x16x32_bf16 v[36:39], v[72:75], a[80:83], v[36:39]
    v_mfma_f32_16x16x32_bf16 v[24:27], a[156:159], a[60:63], v[24:27]
    v_mfma_f32_16x16x32_bf16 v[32:35], a[156:159], a[84:87], v[32:35]
    v_mfma_f32_16x16x32_bf16 v[28:31], v[76:79], a[60:63], v[28:31]
    v_mfma_f32_16x16x32_bf16 v[36:39], v[76:79], a[84:87], v[36:39]
    v_mfma_f32_16x16x32_bf16 v[24:27], v[56:59], a[64:67], v[24:27]
    v_mfma_f32_16x16x32_bf16 v[32:35], v[56:59], a[88:91], v[32:35]
    v_mfma_f32_16x16x32_bf16 v[28:31], v[80:83], a[64:67], v[28:31]
    v_mfma_f32_16x16x32_bf16 v[36:39], v[80:83], a[88:91], v[36:39]
    v_mfma_f32_16x16x32_bf16 v[24:27], v[60:63], a[68:71], v[24:27]
    v_mfma_f32_16x16x32_bf16 v[32:35], v[60:63], a[92:95], v[32:35]
    v_mfma_f32_16x16x32_bf16 v[28:31], v[84:87], a[68:71], v[28:31]
    v_mfma_f32_16x16x32_bf16 v[36:39], v[84:87], a[92:95], v[36:39]
    v_mfma_f32_16x16x32_bf16 v[8:11], a[144:147], a[96:99], 0
    v_mfma_f32_16x16x32_bf16 v[16:19], a[144:147], a[120:123], 0
    v_mfma_f32_16x16x32_bf16 v[12:15], v[64:67], a[96:99], 0
    v_cvt_pk_bf16_f32 v48, v24, v25
    v_cvt_pk_bf16_f32 v49, v26, v27
    v_mfma_f32_16x16x32_bf16 v[20:23], v[64:67], a[120:123], 0
    v_cvt_pk_bf16_f32 v50, v28, v29
    v_cvt_pk_bf16_f32 v51, v30, v31
    v_mfma_f32_16x16x32_bf16 v[8:11], a[148:151], a[100:103], v[8:11]
    ds_write_b128 v6, v[48:51] offset:1024
    v_cvt_pk_bf16_f32 v52, v32, v33
    v_mfma_f32_16x16x32_bf16 v[16:19], a[148:151], a[124:127], v[16:19]
    v_cvt_pk_bf16_f32 v53, v34, v35
    v_cvt_pk_bf16_f32 v54, v36, v37
    v_mfma_f32_16x16x32_bf16 v[12:15], v[68:71], a[100:103], v[12:15]
    v_cvt_pk_bf16_f32 v55, v38, v39
    ds_write_b128 v6, v[52:55] offset:3072
    v_mfma_f32_16x16x32_bf16 v[20:23], v[68:71], a[124:127], v[20:23]
    v_mfma_f32_16x16x32_bf16 v[8:11], a[152:155], a[104:107], v[8:11]
    v_mfma_f32_16x16x32_bf16 v[16:19], a[152:155], a[128:131], v[16:19]
    v_mfma_f32_16x16x32_bf16 v[12:15], v[72:75], a[104:107], v[12:15]
    v_mfma_f32_16x16x32_bf16 v[20:23], v[72:75], a[128:131], v[20:23]
    s_waitcnt lgkmcnt(0)
    s_barrier
L_A_loop23:
    s_mov_b32 s38, s20
    s_add_u32 s20, s20, 24576
    s_cmp_ge_u32 s20, 73728
    s_cselect_b32 s20, 0, s20
    s_sub_u32 s36, s20, s38
    v_add_u32 v1, s36, v1
    v_add_u32 v2, s36, v2
    ds_read_b128 a[144:147], v1 offset:0
    ds_read_b128 v[64:67], v1 offset:6144
    ds_read_b128 a[148:151], v2 offset:0
    ds_read_b128 v[68:71], v2 offset:6144
    ds_read_b128 a[152:155], v1 offset:128
    ds_read_b128 v[72:75], v1 offset:6272
    v_mfma_f32_16x16x32_bf16 v[8:11], a[156:159], a[108:111], v[8:11]
    v_mfma_f32_16x16x32_bf16 v[16:19], a[156:159], a[132:135], v[16:19]
    ds_read_b128 a[156:159], v2 offset:128
    v_mfma_f32_16x16x32_bf16 v[12:15], v[76:79], a[108:111], v[12:15]
    v_mfma_f32_16x16x32_bf16 v[20:23], v[76:79], a[132:135], v[20:23]
    ds_read_b128 v[76:79], v2 offset:6272
    v_mfma_f32_16x16x32_bf16 v[8:11], v[56:59], a[112:115], v[8:11]
    v_mfma_f32_16x16x32_bf16 v[16:19], v[56:59], a[136:139], v[16:19]
    ds_read_b128 v[56:59], v1 offset:256
    v_mfma_f32_16x16x32_bf16 v[12:15], v[80:83], a[112:115], v[12:15]
    v_mfma_f32_16x16x32_bf16 v[20:23], v[80:83], a[136:139], v[20:23]
    ds_read_b128 v[80:83], v1 offset:6400
    v_mfma_f32_16x16x32_bf16 v[8:11], v[60:63], a[116:119], v[8:11]
    v_mfma_f32_16x16x32_bf16 v[16:19], v[60:63], a[140:143], v[16:19]
    ds_read_b128 v[60:63], v2 offset:256
    v_mfma_f32_16x16x32_bf16 v[12:15], v[84:87], a[116:119], v[12:15]
    v_mfma_f32_16x16x32_bf16 v[20:23], v[84:87], a[140:143], v[20:23]
    ds_read_b128 v[84:87], v2 offset:6400
    s_waitcnt lgkmcnt(11)
    v_mfma_f32_16x16x32_bf16 v[24:27], a[0:3], a[144:147], 0
    v_mfma_f32_16x16x32_bf16 v[28:31], a[24:27], a[144:147], 0
    s_waitcnt lgkmcnt(10)
    v_mfma_f32_16x16x32_bf16 v[32:35], a[0:3], v[64:67], 0
    v_cvt_pk_bf16_f32 v40, v8, v9
    v_cvt_pk_bf16_f32 v41, v10, v11
    v_mfma_f32_16x16x32_bf16 v[36:39], a[24:27], v[64:67], 0
    v_cvt_pk_bf16_f32 v42, v12, v13
    v_cvt_pk_bf16_f32 v43, v14, v15
    s_waitcnt lgkmcnt(9)
    v_mfma_f32_16x16x32_bf16 v[24:27], a[4:7], a[148:151], v[24:27]
    ds_write_b128 v6, v[40:43] offset:5120
    v_cvt_pk_bf16_f32 v44, v16, v17
    v_mfma_f32_16x16x32_bf16 v[28:31], a[28:31], a[148:151], v[28:31]
    v_cvt_pk_bf16_f32 v45, v18, v19
    v_cvt_pk_bf16_f32 v46, v20, v21
    s_waitcnt lgkmcnt(9)
    v_mfma_f32_16x16x32_bf16 v[32:35], a[4:7], v[68:71], v[32:35]
    v_cvt_pk_bf16_f32 v47, v22, v23
    ds_write_b128 v6, v[44:47] offset:7168
    v_mfma_f32_16x16x32_bf16 v[36:39], a[28:31], v[68:71], v[36:39]
    s_waitcnt lgkmcnt(9)
    v_mfma_f32_16x16x32_bf16 v[24:27], a[8:11], a[152:155], v[24:27]
    v_mfma_f32_16x16x32_bf16 v[28:31], a[32:35], a[152:155], v[28:31]
    s_waitcnt lgkmcnt(8)
    v_mfma_f32_16x16x32_bf16 v[32:35], a[8:11], v[72:75], v[32:35]
    v_mfma_f32_16x16x32_bf16 v[36:39], a[32:35], v[72:75], v[36:39]
    s_waitcnt lgkmcnt(7)
    v_mfma_f32_16x16x32_bf16 v[24:27], a[12:15], a[156:159], v[24:27]
    s_sub_u32 s21, 0, s21
    v_add_u32 v6, s21, v6
    v_mfma_f32_16x16x32_bf16 v[28:31], a[36:39], a[156:159], v[28:31]
    s_waitcnt lgkmcnt(0)
    s_barrier
    v_mfma_f32_16x16x32_bf16 v[32:35], a[12:15], v[76:79], v[32:35]
    v_mfma_f32_16x16x32_bf16 v[36:39], a[36:39], v[76:79], v[36:39]
    v_mfma_f32_16x16x32_bf16 v[24:27], a[16:19], v[56:59], v[24:27]
    v_mfma_f32_16x16x32_bf16 v[28:31], a[40:43], v[56:59], v[28:31]
    v_mfma_f32_16x16x32_bf16 v[32:35], a[16:19], v[80:83], v[32:35]
    v_mfma_f32_16x16x32_bf16 v[36:39], a[40:43], v[80:83], v[36:39]
    v_mfma_f32_16x16x32_bf16 v[24:27], a[20:23], v[60:63], v[24:27]
    v_mfma_f32_16x16x32_bf16 v[28:31], a[44:47], v[60:63], v[28:31]
    v_mfma_f32_16x16x32_bf16 v[32:35], a[20:23], v[84:87], v[32:35]
    v_mfma_f32_16x16x32_bf16 v[36:39], a[44:47], v[84:87], v[36:39]
    v_mfma_f32_16x16x32_bf16 v[8:11], a[144:147], a[48:51], 0
    v_mfma_f32_16x16x32_bf16 v[16:19], a[144:147], a[72:75], 0
    v_mfma_f32_16x16x32_bf16 v[12:15], v[64:67], a[48:51], 0
    v_cvt_pk_bf16_f32 v48, v24, v25
    v_cvt_pk_bf16_f32 v49, v26, v27
    v_mfma_f32_16x16x32_bf16 v[20:23], v[64:67], a[72:75], 0
    v_cvt_pk_bf16_f32 v50, v28, v29
    v_cvt_pk_bf16_f32 v51, v30, v31
    v_mfma_f32_16x16x32_bf16 v[8:11], a[148:151], a[52:55], v[8:11]
    ds_write_b128 v5, v[48:51] offset:0
    v_cvt_pk_bf16_f32 v52, v32, v33
    v_mfma_f32_16x16x32_bf16 v[16:19], a[148:151], a[76:79], v[16:19]
    v_cvt_pk_bf16_f32 v53, v34, v35
    v_cvt_pk_bf16_f32 v54, v36, v37
    v_mfma_f32_16x16x32_bf16 v[12:15], v[68:71], a[52:55], v[12:15]
    v_cvt_pk_bf16_f32 v55, v38, v39
    ds_write_b128 v5, v[52:55] offset:6144
    v_mfma_f32_16x16x32_bf16 v[20:23], v[68:71], a[76:79], v[20:23]
    v_mfma_f32_16x16x32_bf16 v[8:11], a[152:155], a[56:59], v[8:11]
    v_mfma_f32_16x16x32_bf16 v[16:19], a[152:155], a[80:83], v[16:19]
    v_mfma_f32_16x16x32_bf16 v[12:15], v[72:75], a[56:59], v[12:15]
    v_mfma_f32_16x16x32_bf16 v[20:23], v[72:75], a[80:83], v[20:23]
    v_mfma_f32_16x16x32_bf16 v[8:11], a[156:159], a[60:63], v[8:11]
    v_mfma_f32_16x16x32_bf16 v[16:19], a[156:159], a[84:87], v[16:19]
    v_mfma_f32_16x16x32_bf16 v[12:15], v[76:79], a[60:63], v[12:15]
    v_mfma_f32_16x16x32_bf16 v[20:23], v[76:79], a[84:87], v[20:23]
    v_mfma_f32_16x16x32_bf16 v[8:11], v[56:59], a[64:67], v[8:11]
    v_mfma_f32_16x16x32_bf16 v[16:19], v[56:59], a[88:91], v[16:19]
    v_mfma_f32_16x16x32_bf16 v[12:15], v[80:83], a[64:67], v[12:15]
    v_mfma_f32_16x16x32_bf16 v[20:23], v[80:83], a[88:91], v[20:23]
    v_mfma_f32_16x16x32_bf16 v[8:11], v[60:63], a[68:71], v[8:11]
    v_mfma_f32_16x16x32_bf16 v[16:19], v[60:63], a[92:95], v[16:19]
    v_mfma_f32_16x16x32_bf16 v[12:15], v[84:87], a[68:71], v[12:15]
    v_mfma_f32_16x16x32_bf16 v[20:23], v[84:87], a[92:95], v[20:23]
    v_mfma_f32_16x16x32_bf16 v[24:27], a[144:147], a[96:99], 0
    v_mfma_f32_16x16x32_bf16 v[32:35], a[144:147], a[120:123], 0
    ds_read_b128 a[144:147], v1 offset:12288
    v_mfma_f32_16x16x32_bf16 v[28:31], v[64:67], a[96:99], 0
    v_cvt_pk_bf16_f32 v40, v8, v9
    v_cvt_pk_bf16_f32 v41, v10, v11
    v_mfma_f32_16x16x32_bf16 v[36:39], v[64:67], a[120:123], 0
    ds_read_b128 v[64:67], v1 offset:18432
    v_cvt_pk_bf16_f32 v42, v12, v13
    v_mfma_f32_16x16x32_bf16 v[24:27], a[148:151], a[100:103], v[24:27]
    v_cvt_pk_bf16_f32 v43, v14, v15
    ds_write_b128 v6, v[40:43] offset:0
    v_mfma_f32_16x16x32_bf16 v[32:35], a[148:151], a[124:127], v[32:35]
    ds_read_b128 a[148:151], v2 offset:12288
    v_cvt_pk_bf16_f32 v44, v16, v17
    v_mfma_f32_16x16x32_bf16 v[28:31], v[68:71], a[100:103], v[28:31]
    v_cvt_pk_bf16_f32 v45, v18, v19
    v_cvt_pk_bf16_f32 v46, v20, v21
    v_mfma_f32_16x16x32_bf16 v[36:39], v[68:71], a[124:127], v[36:39]
    ds_read_b128 v[68:71], v2 offset:18432
    v_cvt_pk_bf16_f32 v47, v22, v23
    v_mfma_f32_16x16x32_bf16 v[24:27], a[152:155], a[104:107], v[24:27]
    ds_write_b128 v6, v[44:47] offset:2048
    v_mfma_f32_16x16x32_bf16 v[32:35], a[152:155], a[128:131], v[32:35]
    ds_read_b128 a[152:155], v1 offset:12416
    v_mfma_f32_16x16x32_bf16 v[28:31], v[72:75], a[104:107], v[28:31]
    v_mfma_f32_16x16x32_bf16 v[36:39], v[72:75], a[128:131], v[36:39]
    ds_read_b128 v[72:75], v1 offset:18560
    v_mfma_f32_16x16x32_bf16 v[24:27], a[156:159], a[108:111], v[24:27]
    v_mfma_f32_16x16x32_bf16 v[32:35], a[156:159], a[132:135], v[32:35]
    ds_read_b128 a[156:159], v2 offset:12416
    v_mfma_f32_16x16x32_bf16 v[28:31], v[76:79], a[108:111], v[28:31]
    v_mfma_f32_16x16x32_bf16 v[36:39], v[76:79], a[132:135], v[36:39]
    ds_read_b128 v[76:79], v2 offset:18560
    v_mfma_f32_16x16x32_bf16 v[24:27], v[56:59], a[112:115], v[24:27]
    v_mfma_f32_16x16x32_bf16 v[32:35], v[56:59], a[136:139], v[32:35]
    ds_read_b128 v[56:59], v1 offset:12544
    v_mfma_f32_16x16x32_bf16 v[28:31], v[80:83], a[112:115], v[28:31]
    v_mfma_f32_16x16x32_bf16 v[36:39], v[80:83], a[136:139], v[36:39]
    ds_read_b128 v[80:83], v1 offset:18688
    v_mfma_f32_16x16x32_bf16 v[24:27], v[60:63], a[116:119], v[24:27]
    v_mfma_f32_16x16x32_bf16 v[32:35], v[60:63], a[140:143], v[32:35]
    ds_read_b128 v[60:63], v2 offset:12544
    v_mfma_f32_16x16x32_bf16 v[28:31], v[84:87], a[116:119], v[28:31]
    v_mfma_f32_16x16x32_bf16 v[36:39], v[84:87], a[140:143], v[36:39]
    ds_read_b128 v[84:87], v2 offset:18688
    s_waitcnt lgkmcnt(13)
    v_mfma_f32_16x16x32_bf16 v[8:11], a[0:3], a[144:147], 0
    v_mfma_f32_16x16x32_bf16 v[12:15], a[24:27], a[144:147], 0
    s_waitcnt lgkmcnt(12)
    v_mfma_f32_16x16x32_bf16 v[16:19], a[0:3], v[64:67], 0
    v_cvt_pk_bf16_f32 v48, v24, v25
    v_cvt_pk_bf16_f32 v49, v26, v27
    v_mfma_f32_16x16x32_bf16 v[20:23], a[24:27], v[64:67], 0
    v_cvt_pk_bf16_f32 v50, v28, v29
    v_cvt_pk_bf16_f32 v51, v30, v31
    s_waitcnt lgkmcnt(10)
    v_mfma_f32_16x16x32_bf16 v[8:11], a[4:7], a[148:151], v[8:11]
    ds_write_b128 v6, v[48:51] offset:4096
    v_cvt_pk_bf16_f32 v52, v32, v33
    v_mfma_f32_16x16x32_bf16 v[12:15], a[28:31], a[148:151], v[12:15]
    v_cvt_pk_bf16_f32 v53, v34, v35
    v_cvt_pk_bf16_f32 v54, v36, v37
    s_waitcnt lgkmcnt(10)
    v_mfma_f32_16x16x32_bf16 v[16:19], a[4:7], v[68:71], v[16:19]
    v_cvt_pk_bf16_f32 v55, v38, v39
    ds_write_b128 v6, v[52:55] offset:6144
    v_mfma_f32_16x16x32_bf16 v[20:23], a[28:31], v[68:71], v[20:23]
    s_waitcnt lgkmcnt(9)
    v_mfma_f32_16x16x32_bf16 v[8:11], a[8:11], a[152:155], v[8:11]
    v_mfma_f32_16x16x32_bf16 v[12:15], a[32:35], a[152:155], v[12:15]
    s_waitcnt lgkmcnt(8)
    v_mfma_f32_16x16x32_bf16 v[16:19], a[8:11], v[72:75], v[16:19]
    v_mfma_f32_16x16x32_bf16 v[20:23], a[32:35], v[72:75], v[20:23]
    s_waitcnt lgkmcnt(7)
    v_mfma_f32_16x16x32_bf16 v[8:11], a[12:15], a[156:159], v[8:11]
    v_mfma_f32_16x16x32_bf16 v[12:15], a[36:39], a[156:159], v[12:15]
    s_waitcnt lgkmcnt(6)
    v_mfma_f32_16x16x32_bf16 v[16:19], a[12:15], v[76:79], v[16:19]
    v_mfma_f32_16x16x32_bf16 v[20:23], a[36:39], v[76:79], v[20:23]
    s_waitcnt lgkmcnt(5)
    v_mfma_f32_16x16x32_bf16 v[8:11], a[16:19], v[56:59], v[8:11]
    v_mfma_f32_16x16x32_bf16 v[12:15], a[40:43], v[56:59], v[12:15]
    s_waitcnt lgkmcnt(4)
    v_mfma_f32_16x16x32_bf16 v[16:19], a[16:19], v[80:83], v[16:19]
    v_mfma_f32_16x16x32_bf16 v[20:23], a[40:43], v[80:83], v[20:23]
    s_waitcnt lgkmcnt(3)
    v_mfma_f32_16x16x32_bf16 v[8:11], a[20:23], v[60:63], v[8:11]
    v_mfma_f32_16x16x32_bf16 v[12:15], a[44:47], v[60:63], v[12:15]
    s_waitcnt lgkmcnt(2)
    v_mfma_f32_16x16x32_bf16 v[16:19], a[20:23], v[84:87], v[16:19]
    v_mfma_f32_16x16x32_bf16 v[20:23], a[44:47], v[84:87], v[20:23]
    v_mfma_f32_16x16x32_bf16 v[24:27], a[144:147], a[48:51], 0
    v_mfma_f32_16x16x32_bf16 v[32:35], a[144:147], a[72:75], 0
    v_mfma_f32_16x16x32_bf16 v[28:31], v[64:67], a[48:51], 0
    v_cvt_pk_bf16_f32 v40, v8, v9
    v_cvt_pk_bf16_f32 v41, v10, v11
    v_mfma_f32_16x16x32_bf16 v[36:39], v[64:67], a[72:75], 0
    v_cvt_pk_bf16_f32 v42, v12, v13
    v_cvt_pk_bf16_f32 v43, v14, v15
    v_mfma_f32_16x16x32_bf16 v[24:27], a[148:151], a[52:55], v[24:27]
    ds_write_b128 v5, v[40:43] offset:12288
    v_cvt_pk_bf16_f32 v44, v16, v17
    v_mfma_f32_16x16x32_bf16 v[32:35], a[148:151], a[76:79], v[32:35]
    v_cvt_pk_bf16_f32 v45, v18, v19
    v_cvt_pk_bf16_f32 v46, v20, v21
    v_mfma_f32_16x16x32_bf16 v[28:31], v[68:71], a[52:55], v[28:31]
    v_cvt_pk_bf16_f32 v47, v22, v23
    ds_write_b128 v5, v[44:47] offset:18432
    v_mfma_f32_16x16x32_bf16 v[36:39], v[68:71], a[76:79], v[36:39]
    v_mfma_f32_16x16x32_bf16 v[24:27], a[152:155], a[56:59], v[24:27]
    v_mfma_f32_16x16x32_bf16 v[32:35], a[152:155], a[80:83], v[32:35]
    v_mfma_f32_16x16x32_bf16 v[28:31], v[72:75], a[56:59], v[28:31]
    v_mfma_f32_16x16x32_bf16 v[36:39], v[72:75], a[80:83], v[36:39]
    v_mfma_f32_16x16x32_bf16 v[24:27], a[156:159], a[60:63], v[24:27]
    v_mfma_f32_16x16x32_bf16 v[32:35], a[156:159], a[84:87], v[32:35]
    v_mfma_f32_16x16x32_bf16 v[28:31], v[76:79], a[60:63], v[28:31]
    v_mfma_f32_16x16x32_bf16 v[36:39], v[76:79], a[84:87], v[36:39]
    v_mfma_f32_16x16x32_bf16 v[24:27], v[56:59], a[64:67], v[24:27]
    v_mfma_f32_16x16x32_bf16 v[32:35], v[56:59], a[88:91], v[32:35]
    v_mfma_f32_16x16x32_bf16 v[28:31], v[80:83], a[64:67], v[28:31]
    v_mfma_f32_16x16x32_bf16 v[36:39], v[80:83], a[88:91], v[36:39]
    v_mfma_f32_16x16x32_bf16 v[24:27], v[60:63], a[68:71], v[24:27]
    v_mfma_f32_16x16x32_bf16 v[32:35], v[60:63], a[92:95], v[32:35]
    v_mfma_f32_16x16x32_bf16 v[28:31], v[84:87], a[68:71], v[28:31]
    v_mfma_f32_16x16x32_bf16 v[36:39], v[84:87], a[92:95], v[36:39]
    v_mfma_f32_16x16x32_bf16 v[8:11], a[144:147], a[96:99], 0
    v_mfma_f32_16x16x32_bf16 v[16:19], a[144:147], a[120:123], 0
    v_mfma_f32_16x16x32_bf16 v[12:15], v[64:67], a[96:99], 0
    v_cvt_pk_bf16_f32 v48, v24, v25
    v_cvt_pk_bf16_f32 v49, v26, v27
    v_mfma_f32_16x16x32_bf16 v[20:23], v[64:67], a[120:123], 0
    v_cvt_pk_bf16_f32 v50, v28, v29
    v_cvt_pk_bf16_f32 v51, v30, v31
    v_mfma_f32_16x16x32_bf16 v[8:11], a[148:151], a[100:103], v[8:11]
    ds_write_b128 v6, v[48:51] offset:1024
    v_cvt_pk_bf16_f32 v52, v32, v33
    v_mfma_f32_16x16x32_bf16 v[16:19], a[148:151], a[124:127], v[16:19]
    v_cvt_pk_bf16_f32 v53, v34, v35
    v_cvt_pk_bf16_f32 v54, v36, v37
    v_mfma_f32_16x16x32_bf16 v[12:15], v[68:71], a[100:103], v[12:15]
    v_cvt_pk_bf16_f32 v55, v38, v39
    ds_write_b128 v6, v[52:55] offset:3072
    v_mfma_f32_16x16x32_bf16 v[20:23], v[68:71], a[124:127], v[20:23]
    v_mfma_f32_16x16x32_bf16 v[8:11], a[152:155], a[104:107], v[8:11]
    v_mfma_f32_16x16x32_bf16 v[16:19], a[152:155], a[128:131], v[16:19]
    v_mfma_f32_16x16x32_bf16 v[12:15], v[72:75], a[104:107], v[12:15]
    v_mfma_f32_16x16x32_bf16 v[20:23], v[72:75], a[128:131], v[20:23]
    s_add_u32 s17, s17, 1
    s_waitcnt lgkmcnt(0)
    s_barrier
    s_cmp_lt_u32 s17, 8
    s_cbranch_scc1 L_A_loop23
    v_mfma_f32_16x16x32_bf16 v[8:11], a[156:159], a[108:111], v[8:11]
    v_mfma_f32_16x16x32_bf16 v[16:19], a[156:159], a[132:135], v[16:19]
    v_mfma_f32_16x16x32_bf16 v[12:15], v[76:79], a[108:111], v[12:15]
    v_mfma_f32_16x16x32_bf16 v[20:23], v[76:79], a[132:135], v[20:23]
    v_mfma_f32_16x16x32_bf16 v[8:11], v[56:59], a[112:115], v[8:11]
    v_mfma_f32_16x16x32_bf16 v[16:19], v[56:59], a[136:139], v[16:19]
    v_mfma_f32_16x16x32_bf16 v[12:15], v[80:83], a[112:115], v[12:15]
    v_mfma_f32_16x16x32_bf16 v[20:23], v[80:83], a[136:139], v[20:23]
    v_mfma_f32_16x16x32_bf16 v[8:11], v[60:63], a[116:119], v[8:11]
    v_mfma_f32_16x16x32_bf16 v[16:19], v[60:63], a[140:143], v[16:19]
    v_mfma_f32_16x16x32_bf16 v[12:15], v[84:87], a[116:119], v[12:15]
    v_mfma_f32_16x16x32_bf16 v[20:23], v[84:87], a[140:143], v[20:23]
    v_cvt_pk_bf16_f32 v40, v8, v9
    v_cvt_pk_bf16_f32 v41, v10, v11
    s_nop 1
    v_cvt_pk_bf16_f32 v42, v12, v13
    v_cvt_pk_bf16_f32 v43, v14, v15
    ds_write_b128 v6, v[40:43] offset:5120
    v_cvt_pk_bf16_f32 v44, v16, v17
    v_cvt_pk_bf16_f32 v45, v18, v19
    v_cvt_pk_bf16_f32 v46, v20, v21
    v_cvt_pk_bf16_f32 v47, v22, v23
    ds_write_b128 v6, v[44:47] offset:7168
    s_waitcnt lgkmcnt(0)
    s_barrier
    s_endpgm
L_B_role:
    s_setprio 2
    v_and_b32 v14, 63, v0
    v_and_b32 v15, 15, v14
    v_lshrrev_b32 v16, 4, v14
    s_mul_i32 s32, s16, 294912
    s_mul_i32 s25, s16, 6144
    v_add_u32 v18, 0, v14
    v_mul_u32_u24 v19, 171, v18
    v_lshrrev_b32 v19, 12, v19
    v_mul_u32_u24 v20, 24, v19
    v_sub_u32 v20, v18, v20
    v_lshrrev_b32 v21, 1, v19
    v_add_u32 v21, 0, v21
    v_xor_b32 v20, v20, v21
    v_lshlrev_b32 v20, 4, v20
    v_mul_u32_u24 v19, 384, v19
    v_add_u32 v19, v19, v20
    v_add_u32 v19, 0, v19
    v_add_u32 v3, s32, v19
    v_add_u32 v18, 64, v14
    v_mul_u32_u24 v19, 171, v18
    v_lshrrev_b32 v19, 12, v19
    v_mul_u32_u24 v20, 24, v19
    v_sub_u32 v20, v18, v20
    v_lshrrev_b32 v21, 1, v19
    v_add_u32 v21, 0, v21
    v_xor_b32 v20, v20, v21
    v_lshlrev_b32 v20, 4, v20
    v_mul_u32_u24 v19, 384, v19
    v_add_u32 v19, v19, v20
    v_add_u32 v19, 4294966272, v19
    v_add_u32 v4, s32, v19
    v_add_u32 v18, 128, v14
    v_mul_u32_u24 v19, 171, v18
    v_lshrrev_b32 v19, 12, v19
    v_mul_u32_u24 v20, 24, v19
    v_sub_u32 v20, v18, v20
    v_lshrrev_b32 v21, 1, v19
    v_add_u32 v21, 0, v21
    v_xor_b32 v20, v20, v21
    v_lshlrev_b32 v20, 4, v20
    v_mul_u32_u24 v19, 384, v19
    v_add_u32 v19, v19, v20
    v_add_u32 v19, 4294965248, v19
    v_add_u32 v5, s32, v19
    v_add_u32 v18, 0, v14
    v_mul_u32_u24 v19, 171, v18
    v_lshrrev_b32 v19, 12, v19
    v_mul_u32_u24 v20, 24, v19
    v_sub_u32 v20, v18, v20
    v_lshrrev_b32 v21, 1, v19
    v_add_u32 v21, 4, v21
    v_xor_b32 v20, v20, v21
    v_lshlrev_b32 v20, 4, v20
    v_mul_u32_u24 v19, 384, v19
    v_add_u32 v19, v19, v20
    v_add_u32 v19, 147456, v19
    v_add_u32 v6, s32, v19
    v_add_u32 v18, 64, v14
    v_mul_u32_u24 v19, 171, v18
    v_lshrrev_b32 v19, 12, v19
    v_mul_u32_u24 v20, 24, v19
    v_sub_u32 v20, v18, v20
    v_lshrrev_b32 v21, 1, v19
    v_add_u32 v21, 4, v21
    v_xor_b32 v20, v20, v21
    v_lshlrev_b32 v20, 4, v20
    v_mul_u32_u24 v19, 384, v19
    v_add_u32 v19, v19, v20
    v_add_u32 v19, 146432, v19
    v_add_u32 v7, s32, v19
    v_add_u32 v18, 128, v14
    v_mul_u32_u24 v19, 171, v18
    v_lshrrev_b32 v19, 12, v19
    v_mul_u32_u24 v20, 24, v19
    v_sub_u32 v20, v18, v20
    v_lshrrev_b32 v21, 1, v19
    v_add_u32 v21, 4, v21
    v_xor_b32 v20, v20, v21
    v_lshlrev_b32 v20, 4, v20
    v_mul_u32_u24 v19, 384, v19
    v_add_u32 v19, v19, v20
    v_add_u32 v19, 145408, v19
    v_add_u32 v8, s32, v19
    s_add_u32 s28, s24, 0
    s_mul_i32 s26, s28, 43691
    s_lshr_b32 s26, s26, 21
    s_mul_i32 s27, s26, 48
    s_sub_u32 s27, s28, s27
    s_mul_i32 s26, s26, 1179648
    s_mul_i32 s27, s27, 3072
    s_add_u32 s18, s26, s27
    s_add_u32 s22, s25, 0
    s_add_u32 s23, s25, 3072
    s_mov_b32 m0, s22
    s_nop 0
    buffer_load_dwordx4 v3, s[4:7], s18 offen offset:0 nt lds
    buffer_load_dwordx4 v4, s[4:7], s18 offen offset:1024 nt lds
    buffer_load_dwordx4 v5, s[4:7], s18 offen offset:2048 nt lds
    s_mov_b32 m0, s23
    s_nop 0
    buffer_load_dwordx4 v6, s[4:7], s18 offen offset:0 nt lds
    buffer_load_dwordx4 v7, s[4:7], s18 offen offset:1024 nt lds
    buffer_load_dwordx4 v8, s[4:7], s18 offen offset:2048 nt lds
    v_lshrrev_b32 v17, 1, v15
    v_mul_u32_u24 v18, 384, v15
    v_xor_b32 v19, v16, v17
    v_lshl_add_u32 v1, v19, 4, v18
    v_xor_b32 v19, 4, v19
    v_lshl_add_u32 v2, v19, 4, v18
    v_lshrrev_b32 v18, 1, v16
    s_mov_b32 s33, 147456
    v_mul_lo_u32 v18, v18, s33
    v_and_b32 v19, 1, v16
    v_mul_u32_u24 v19, 1536, v19
    v_add3_u32 v18, v18, v19, s32
    v_lshl_add_u32 v11, v15, 4, v18
    v_lshl_add_u32 v12, v15, 3, v18
    v_add_u32 v12, 256, v12
    v_lshlrev_b32 v18, 4, v14
    v_add_u32 v10, 98304, v18
    s_add_u32 s34, s25, 73728
    v_add_u32 v9, s34, v18
    s_mov_b32 s20, 0
    s_mov_b32 s21, 4294942720
    s_mov_b32 s17, 0
    s_waitcnt vmcnt(0)
    s_barrier
    s_add_u32 s28, s24, 256
    s_mul_i32 s26, s28, 43691
    s_lshr_b32 s26, s26, 21
    s_mul_i32 s27, s26, 48
    s_sub_u32 s27, s28, s27
    s_mul_i32 s26, s26, 1179648
    s_mul_i32 s27, s27, 3072
    s_add_u32 s18, s26, s27
    s_add_u32 s22, s25, 24576
    s_add_u32 s23, s25, 27648
    s_mov_b32 m0, s22
    s_nop 0
    buffer_load_dwordx4 v3, s[4:7], s18 offen offset:0 nt lds
    buffer_load_dwordx4 v4, s[4:7], s18 offen offset:1024 nt lds
    buffer_load_dwordx4 v5, s[4:7], s18 offen offset:2048 nt lds
    s_mov_b32 m0, s23
    s_nop 0
    buffer_load_dwordx4 v6, s[4:7], s18 offen offset:0 nt lds
    buffer_load_dwordx4 v7, s[4:7], s18 offen offset:1024 nt lds
    buffer_load_dwordx4 v8, s[4:7], s18 offen offset:2048 nt lds
    s_add_u32 s28, s24, 512
    s_mul_i32 s26, s28, 43691
    s_lshr_b32 s26, s26, 21
    s_mul_i32 s27, s26, 48
    s_sub_u32 s27, s28, s27
    s_mul_i32 s26, s26, 1179648
    s_mul_i32 s27, s27, 3072
    s_add_u32 s18, s26, s27
    s_add_u32 s22, s25, 49152
    s_add_u32 s23, s25, 52224
    s_mov_b32 m0, s22
    s_nop 0
    buffer_load_dwordx4 v3, s[4:7], s18 offen offset:0 nt lds
    buffer_load_dwordx4 v4, s[4:7], s18 offen offset:1024 nt lds
    buffer_load_dwordx4 v5, s[4:7], s18 offen offset:2048 nt lds
    s_mov_b32 m0, s23
    s_nop 0
    buffer_load_dwordx4 v6, s[4:7], s18 offen offset:0 nt lds
    buffer_load_dwordx4 v7, s[4:7], s18 offen offset:1024 nt lds
    buffer_load_dwordx4 v8, s[4:7], s18 offen offset:2048 nt lds
    ds_read_b128 a[0:3], v1 offset:0
    ds_read_b128 a[4:7], v2 offset:0
    ds_read_b128 a[8:11], v1 offset:128
    ds_read_b128 a[12:15], v2 offset:128
    ds_read_b128 a[16:19], v1 offset:256
    ds_read_b128 a[20:23], v2 offset:256
    ds_read_b128 a[24:27], v1 offset:6144
    ds_read_b128 a[28:31], v2 offset:6144
    ds_read_b128 a[32:35], v1 offset:6272
    ds_read_b128 a[36:39], v2 offset:6272
    ds_read_b128 a[40:43], v1 offset:6400
    ds_read_b128 a[44:47], v2 offset:6400
    ds_read_b128 a[48:51], v1 offset:12288
    ds_read_b128 a[52:55], v2 offset:12288
    ds_read_b128 a[56:59], v1 offset:12416
    ds_read_b128 a[60:63], v2 offset:12416
    ds_read_b128 a[64:67], v1 offset:12544
    ds_read_b128 a[68:71], v2 offset:12544
    ds_read_b128 a[72:75], v1 offset:18432
    ds_read_b128 a[76:79], v2 offset:18432
    ds_read_b128 a[80:83], v1 offset:18560
    ds_read_b128 a[84:87], v2 offset:18560
    ds_read_b128 a[88:91], v1 offset:18688
    ds_read_b128 a[92:95], v2 offset:18688
    s_waitcnt vmcnt(6) lgkmcnt(0)
    s_barrier
L_B_loop:
    ds_read_b128 a[96:99], v9 offset:0
    ds_read_b128 a[100:103], v9 offset:1024
    ds_read_b128 a[104:107], v9 offset:2048
    ds_read_b128 a[108:111], v9 offset:3072
    ds_read_b128 a[112:115], v9 offset:4096
    ds_read_b128 a[116:119], v9 offset:5120
    s_mul_i32 s28, s17, 256
    s_add_u32 s28, s28, s24
    s_sub_u32 s29, s28, 256
    s_cmp_eq_u32 s17, 0
    s_cselect_b32 s29, 0, s29
    s_mul_i32 s26, s29, 43691
    s_lshr_b32 s26, s26, 21
    s_mul_i32 s27, s26, 48
    s_sub_u32 s27, s29, s27
    s_mul_i32 s26, s26, 1179648
    s_mul_i32 s27, s27, 3072
    s_add_u32 s19, s26, s27
    s_cmp_eq_u32 s17, 0
    s_cselect_b32 s19, 0x80000000, s19
    s_add_u32 s29, s28, 768
    s_mul_i32 s26, s29, 43691
    s_lshr_b32 s26, s26, 21
    s_mul_i32 s27, s26, 48
    s_sub_u32 s27, s29, s27
    s_mul_i32 s26, s26, 1179648
    s_mul_i32 s27, s27, 3072
    s_add_u32 s18, s26, s27
    s_cmp_ge_u32 s17, 6
    s_cselect_b32 s18, 0x80000000, s18
    s_add_u32 s22, s20, s25
    s_add_u32 s23, s22, 3072
    s_mov_b32 s38, s20
    s_add_u32 s20, s20, 24576
    s_cmp_ge_u32 s20, 73728
    s_cselect_b32 s20, 0, s20
    s_sub_u32 s36, s20, s38
    v_add_u32 v1, s36, v1
    v_add_u32 v2, s36, v2
    s_mov_b32 m0, s22
    s_nop 0
    buffer_load_dwordx4 v3, s[4:7], s18 offen offset:0 nt lds
    buffer_store_dwordx4 v[64:67], v11, s[8:11], s19 offen offset:0 sc1
    s_waitcnt lgkmcnt(5)
    v_mfma_f32_16x16x32_bf16 v[24:27], a[0:3], a[96:99], 0
    s_waitcnt lgkmcnt(4)
    v_mfma_f32_16x16x32_bf16 v[24:27], a[4:7], a[100:103], v[24:27]
    s_waitcnt lgkmcnt(3)
    v_mfma_f32_16x16x32_bf16 v[24:27], a[8:11], a[104:107], v[24:27]
    s_waitcnt lgkmcnt(2)
    v_mfma_f32_16x16x32_bf16 v[24:27], a[12:15], a[108:111], v[24:27]
    s_waitcnt lgkmcnt(1)
    v_mfma_f32_16x16x32_bf16 v[24:27], a[16:19], a[112:115], v[24:27]
    s_waitcnt lgkmcnt(0)
    v_mfma_f32_16x16x32_bf16 v[24:27], a[20:23], a[116:119], v[24:27]
    ds_read_b128 a[0:3], v1 offset:0
    ds_read_b128 a[4:7], v2 offset:0
    v_mfma_f32_16x16x32_bf16 v[28:31], a[24:27], a[96:99], 0
    ds_read_b128 a[8:11], v1 offset:128
    ds_read_b128 a[12:15], v2 offset:128
    v_mfma_f32_16x16x32_bf16 v[28:31], a[28:31], a[100:103], v[28:31]
    ds_read_b128 a[16:19], v1 offset:256
    ds_read_b128 a[20:23], v2 offset:256
    v_mfma_f32_16x16x32_bf16 v[28:31], a[32:35], a[104:107], v[28:31]
    v_mfma_f32_16x16x32_bf16 v[28:31], a[36:39], a[108:111], v[28:31]
    s_mov_b32 m0, s22
    s_nop 0
    buffer_load_dwordx4 v4, s[4:7], s18 offen offset:1024 nt lds
    v_mfma_f32_16x16x32_bf16 v[28:31], a[40:43], a[112:115], v[28:31]
    v_mfma_f32_16x16x32_bf16 v[28:31], a[44:47], a[116:119], v[28:31]
    ds_read_b128 a[24:27], v1 offset:6144
    ds_read_b128 a[28:31], v2 offset:6144
    v_mfma_f32_16x16x32_bf16 v[32:35], a[48:51], a[96:99], 0
    ds_read_b128 a[32:35], v1 offset:6272
    ds_read_b128 a[36:39], v2 offset:6272
    v_mfma_f32_16x16x32_bf16 v[32:35], a[52:55], a[100:103], v[32:35]
    ds_read_b128 a[40:43], v1 offset:6400
    ds_read_b128 a[44:47], v2 offset:6400
    v_mfma_f32_16x16x32_bf16 v[32:35], a[56:59], a[104:107], v[32:35]
    v_mfma_f32_16x16x32_bf16 v[32:35], a[60:63], a[108:111], v[32:35]
    buffer_store_dwordx4 v[68:71], v11, s[8:11], s19 offen offset:384 sc1
    v_mfma_f32_16x16x32_bf16 v[32:35], a[64:67], a[112:115], v[32:35]
    v_mfma_f32_16x16x32_bf16 v[32:35], a[68:71], a[116:119], v[32:35]
    ds_read_b128 a[48:51], v1 offset:12288
    ds_read_b128 a[52:55], v2 offset:12288
    v_mfma_f32_16x16x32_bf16 v[36:39], a[72:75], a[96:99], 0
    ds_read_b128 a[56:59], v1 offset:12416
    ds_read_b128 a[60:63], v2 offset:12416
    v_mfma_f32_16x16x32_bf16 v[36:39], a[76:79], a[100:103], v[36:39]
    ds_read_b128 a[64:67], v1 offset:12544
    ds_read_b128 a[68:71], v2 offset:12544
    v_mfma_f32_16x16x32_bf16 v[36:39], a[80:83], a[104:107], v[36:39]
    v_mfma_f32_16x16x32_bf16 v[36:39], a[84:87], a[108:111], v[36:39]
    v_mfma_f32_16x16x32_bf16 v[36:39], a[88:91], a[112:115], v[36:39]
    v_mfma_f32_16x16x32_bf16 v[36:39], a[92:95], a[116:119], v[36:39]
    ds_read_b128 a[72:75], v1 offset:18432
    ds_read_b128 a[76:79], v2 offset:18432
    ds_read_b128 a[80:83], v1 offset:18560
    ds_read_b128 a[84:87], v2 offset:18560
    ds_read_b128 a[88:91], v1 offset:18688
    ds_read_b128 a[92:95], v2 offset:18688
    s_mov_b32 m0, s22
    s_nop 0
    buffer_load_dwordx4 v5, s[4:7], s18 offen offset:2048 nt lds
    buffer_store_dwordx4 v[72:75], v11, s[8:11], s19 offen offset:768 sc1
    s_setprio 0
    s_barrier
    v_max3_f32 v14, v24, v25, v26
    v_max3_f32 v15, v27, v28, v29
    v_max3_f32 v14, v14, v30, v31
    v_max3_f32 v15, v15, v32, v33
    v_max3_f32 v14, v14, v34, v35
    v_max3_f32 v15, v15, v36, v37
    v_max3_f32 v14, v14, v38, v39
    v_max_f32 v14, v14, v15
    v_mov_b32 v15, v14
    s_mov_b32 m0, s23
    s_nop 0
    buffer_load_dwordx4 v6, s[4:7], s18 offen offset:0 nt lds
    v_permlane32_swap_b32 v14, v15
    v_max_f32 v14, v14, v15
    v_mov_b32 v15, v14
    s_nop 1
    v_permlane16_swap_b32 v14, v15
    v_max_f32 v14, v14, v15
    v_sub_f32 v24, v24, v14
    v_sub_f32 v25, v25, v14
    v_sub_f32 v26, v26, v14
    v_sub_f32 v27, v27, v14
    v_sub_f32 v28, v28, v14
    v_sub_f32 v29, v29, v14
    v_sub_f32 v30, v30, v14
    v_sub_f32 v31, v31, v14
    v_sub_f32 v32, v32, v14
    v_sub_f32 v33, v33, v14
    v_sub_f32 v34, v34, v14
    buffer_store_dwordx4 v[76:79], v11, s[8:11], s19 offen offset:1152 sc1
    v_sub_f32 v35, v35, v14
    v_sub_f32 v36, v36, v14
    v_sub_f32 v37, v37, v14
    v_sub_f32 v38, v38, v14
    v_sub_f32 v39, v39, v14
    v_exp_f32 v24, v24
    v_exp_f32 v25, v25
    v_exp_f32 v26, v26
    v_exp_f32 v27, v27
    v_exp_f32 v28, v28
    v_exp_f32 v29, v29
    v_exp_f32 v30, v30
    v_exp_f32 v31, v31
    v_exp_f32 v32, v32
    v_exp_f32 v33, v33
    v_exp_f32 v34, v34
    s_mov_b32 m0, s23
    s_nop 0
    buffer_load_dwordx4 v7, s[4:7], s18 offen offset:1024 nt lds
    v_exp_f32 v35, v35
    v_exp_f32 v36, v36
    v_exp_f32 v37, v37
    v_exp_f32 v38, v38
    v_exp_f32 v39, v39
    v_add_f32 v16, v24, v25
    v_add_f32 v17, v26, v27
    v_add_f32 v16, v16, v28
    ds_read_b128 a[120:123], v10 offset:0
    v_add_f32 v17, v17, v29
    v_add_f32 v16, v16, v30
    v_add_f32 v17, v17, v31
    v_add_f32 v16, v16, v32
    ds_read_b128 a[124:127], v10 offset:1024
    v_add_f32 v17, v17, v33
    v_add_f32 v16, v16, v34
    v_add_f32 v17, v17, v35
    v_add_f32 v16, v16, v36
    buffer_store_dwordx2 v[80:81], v12, s[8:11], s19 offen offset:0 sc1
    ds_read_b128 a[128:131], v10 offset:2048
    v_add_f32 v17, v17, v37
    v_add_f32 v16, v16, v38
    v_add_f32 v17, v17, v39
    v_add_f32 v16, v16, v17
    ds_read_b128 a[132:135], v10 offset:3072
    v_mov_b32 v15, v16
    s_nop 1
    v_permlane32_swap_b32 v16, v15
    v_add_f32 v16, v16, v15
    v_mov_b32 v15, v16
    ds_read_b128 a[136:139], v10 offset:4096
    s_nop 0
    v_permlane16_swap_b32 v16, v15
    v_add_f32 v16, v16, v15
    v_rcp_f32 v16, v16
    s_nop 0
    v_mul_f32 v24, v24, v16
    ds_read_b128 a[140:143], v10 offset:5120
    v_mul_f32 v25, v25, v16
    v_mul_f32 v26, v26, v16
    v_mul_f32 v27, v27, v16
    v_mul_f32 v28, v28, v16
    buffer_store_dwordx2 v[82:83], v12, s[8:11], s19 offen offset:384 sc1
    ds_read_b128 a[144:147], v10 offset:6144
    v_mul_f32 v29, v29, v16
    v_mul_f32 v30, v30, v16
    v_mul_f32 v31, v31, v16
    v_mul_f32 v32, v32, v16
    ds_read_b128 a[148:151], v10 offset:7168
    v_mul_f32 v33, v33, v16
    v_mul_f32 v34, v34, v16
    v_mul_f32 v35, v35, v16
    v_mul_f32 v36, v36, v16
    v_mul_f32 v37, v37, v16
    v_mul_f32 v38, v38, v16
    v_mul_f32 v39, v39, v16
    v_cvt_pk_bf16_f32 v40, v24, v25
    v_cvt_pk_bf16_f32 v41, v26, v27
    v_cvt_pk_bf16_f32 v42, v28, v29
    v_cvt_pk_bf16_f32 v43, v30, v31
    v_cvt_pk_bf16_f32 v44, v32, v33
    v_cvt_pk_bf16_f32 v45, v34, v35
    v_cvt_pk_bf16_f32 v46, v36, v37
    v_cvt_pk_bf16_f32 v47, v38, v39
    s_setprio 2
    s_waitcnt lgkmcnt(7)
    v_mfma_f32_16x16x32_bf16 v[48:51], v[40:43], a[120:123], 0
    ds_read_b128 a[120:123], v10 offset:8192
    s_waitcnt lgkmcnt(7)
    v_mfma_f32_16x16x32_bf16 v[48:51], v[44:47], a[124:127], v[48:51]
    ds_read_b128 a[124:127], v10 offset:9216
    s_waitcnt lgkmcnt(7)
    v_mfma_f32_16x16x32_bf16 v[52:55], v[40:43], a[128:131], 0
    ds_read_b128 a[128:131], v10 offset:10240
    s_waitcnt lgkmcnt(7)
    v_mfma_f32_16x16x32_bf16 v[52:55], v[44:47], a[132:135], v[52:55]
    ds_read_b128 a[132:135], v10 offset:11264
    s_waitcnt lgkmcnt(7)
    v_mfma_f32_16x16x32_bf16 v[56:59], v[40:43], a[136:139], 0
    ds_read_b128 a[136:139], v10 offset:12288
    s_waitcnt lgkmcnt(7)
    v_mfma_f32_16x16x32_bf16 v[56:59], v[44:47], a[140:143], v[56:59]
    ds_read_b128 a[140:143], v10 offset:13312
    v_cvt_pk_bf16_f32 v64, v48, v52
    s_waitcnt lgkmcnt(7)
    v_mfma_f32_16x16x32_bf16 v[60:63], v[40:43], a[144:147], 0
    ds_read_b128 a[144:147], v10 offset:14336
    v_cvt_pk_bf16_f32 v68, v49, v53
    s_waitcnt lgkmcnt(7)
    v_mfma_f32_16x16x32_bf16 v[60:63], v[44:47], a[148:151], v[60:63]
    ds_read_b128 a[148:151], v10 offset:15360
    v_cvt_pk_bf16_f32 v72, v50, v54
    v_cvt_pk_bf16_f32 v76, v51, v55
    s_waitcnt lgkmcnt(7)
    v_mfma_f32_16x16x32_bf16 v[48:51], v[40:43], a[120:123], 0
    ds_read_b128 a[120:123], v10 offset:16384
    buffer_store_dwordx2 v[84:85], v12, s[8:11], s19 offen offset:768 sc1
    s_waitcnt lgkmcnt(7)
    v_mfma_f32_16x16x32_bf16 v[48:51], v[44:47], a[124:127], v[48:51]
    ds_read_b128 a[124:127], v10 offset:17408
    v_cvt_pk_bf16_f32 v65, v56, v60
    s_waitcnt lgkmcnt(7)
    v_mfma_f32_16x16x32_bf16 v[52:55], v[40:43], a[128:131], 0
    ds_read_b128 a[128:131], v10 offset:18432
    v_cvt_pk_bf16_f32 v69, v57, v61
    s_waitcnt lgkmcnt(7)
    v_mfma_f32_16x16x32_bf16 v[52:55], v[44:47], a[132:135], v[52:55]
    ds_read_b128 a[132:135], v10 offset:19456
    v_cvt_pk_bf16_f32 v73, v58, v62
    v_cvt_pk_bf16_f32 v77, v59, v63
    s_waitcnt lgkmcnt(7)
    v_mfma_f32_16x16x32_bf16 v[56:59], v[40:43], a[136:139], 0
    ds_read_b128 a[136:139], v10 offset:20480
    buffer_store_dwordx2 v[86:87], v12, s[8:11], s19 offen offset:1152 sc1
    s_waitcnt lgkmcnt(7)
    v_mfma_f32_16x16x32_bf16 v[56:59], v[44:47], a[140:143], v[56:59]
    ds_read_b128 a[140:143], v10 offset:21504
    v_cvt_pk_bf16_f32 v66, v48, v52
    s_waitcnt lgkmcnt(7)
    v_mfma_f32_16x16x32_bf16 v[60:63], v[40:43], a[144:147], 0
    ds_read_b128 a[144:147], v10 offset:22528
    v_cvt_pk_bf16_f32 v70, v49, v53
    s_waitcnt lgkmcnt(7)
    v_mfma_f32_16x16x32_bf16 v[60:63], v[44:47], a[148:151], v[60:63]
    ds_read_b128 a[148:151], v10 offset:23552
    v_cvt_pk_bf16_f32 v74, v50, v54
    v_cvt_pk_bf16_f32 v78, v51, v55
    s_waitcnt lgkmcnt(7)
    v_mfma_f32_16x16x32_bf16 v[48:51], v[40:43], a[120:123], 0
    s_waitcnt lgkmcnt(6)
    v_mfma_f32_16x16x32_bf16 v[48:51], v[44:47], a[124:127], v[48:51]
    v_cvt_pk_bf16_f32 v67, v56, v60
    v_cvt_pk_bf16_f32 v71, v57, v61
    s_waitcnt lgkmcnt(5)
    v_mfma_f32_16x16x32_bf16 v[52:55], v[40:43], a[128:131], 0
    v_cvt_pk_bf16_f32 v75, v58, v62
    v_cvt_pk_bf16_f32 v79, v59, v63
    s_waitcnt lgkmcnt(4)
    v_mfma_f32_16x16x32_bf16 v[52:55], v[44:47], a[132:135], v[52:55]
    s_waitcnt lgkmcnt(3)
    v_mfma_f32_16x16x32_bf16 v[56:59], v[40:43], a[136:139], 0
    s_waitcnt lgkmcnt(2)
    v_mfma_f32_16x16x32_bf16 v[56:59], v[44:47], a[140:143], v[56:59]
    v_cvt_pk_bf16_f32 v80, v48, v52
    v_cvt_pk_bf16_f32 v82, v49, v53
    s_waitcnt lgkmcnt(1)
    v_mfma_f32_16x16x32_bf16 v[60:63], v[40:43], a[144:147], 0
    v_cvt_pk_bf16_f32 v84, v50, v54
    v_cvt_pk_bf16_f32 v86, v51, v55
    s_waitcnt lgkmcnt(0)
    v_mfma_f32_16x16x32_bf16 v[60:63], v[44:47], a[148:151], v[60:63]
    s_nop 7
    v_cvt_pk_bf16_f32 v81, v56, v60
    v_cvt_pk_bf16_f32 v83, v57, v61
    v_cvt_pk_bf16_f32 v85, v58, v62
    v_cvt_pk_bf16_f32 v87, v59, v63
    s_mov_b32 m0, s23
    s_nop 0
    buffer_load_dwordx4 v8, s[4:7], s18 offen offset:2048 nt lds
    s_sub_u32 s21, 0, s21
    v_add_u32 v10, s21, v10
    s_add_u32 s17, s17, 1
    s_waitcnt vmcnt(14) lgkmcnt(0)
    s_barrier
    s_cmp_lt_u32 s17, 8
    s_cbranch_scc1 L_B_loop
    ds_read_b128 a[96:99], v9 offset:0
    ds_read_b128 a[100:103], v9 offset:1024
    ds_read_b128 a[104:107], v9 offset:2048
    ds_read_b128 a[108:111], v9 offset:3072
    ds_read_b128 a[112:115], v9 offset:4096
    ds_read_b128 a[116:119], v9 offset:5120
    s_mul_i32 s28, s17, 256
    s_add_u32 s28, s28, s24
    s_sub_u32 s29, s28, 256
    s_cmp_eq_u32 s17, 0
    s_cselect_b32 s29, 0, s29
    s_mul_i32 s26, s29, 43691
    s_lshr_b32 s26, s26, 21
    s_mul_i32 s27, s26, 48
    s_sub_u32 s27, s29, s27
    s_mul_i32 s26, s26, 1179648
    s_mul_i32 s27, s27, 3072
    s_add_u32 s19, s26, s27
    s_cmp_eq_u32 s17, 0
    s_cselect_b32 s19, 0x80000000, s19
    s_mul_i32 s26, s28, 43691
    s_lshr_b32 s26, s26, 21
    s_mul_i32 s27, s26, 48
    s_sub_u32 s27, s28, s27
    s_mul_i32 s26, s26, 1179648
    s_mul_i32 s27, s27, 3072
    s_add_u32 s18, s26, s27
    buffer_store_dwordx4 v[64:67], v11, s[8:11], s19 offen offset:0 sc1
    s_waitcnt lgkmcnt(5)
    v_mfma_f32_16x16x32_bf16 v[24:27], a[0:3], a[96:99], 0
    s_waitcnt lgkmcnt(4)
    v_mfma_f32_16x16x32_bf16 v[24:27], a[4:7], a[100:103], v[24:27]
    s_waitcnt lgkmcnt(3)
    v_mfma_f32_16x16x32_bf16 v[24:27], a[8:11], a[104:107], v[24:27]
    s_waitcnt lgkmcnt(2)
    v_mfma_f32_16x16x32_bf16 v[24:27], a[12:15], a[108:111], v[24:27]
    s_waitcnt lgkmcnt(1)
    v_mfma_f32_16x16x32_bf16 v[24:27], a[16:19], a[112:115], v[24:27]
    s_waitcnt lgkmcnt(0)
    v_mfma_f32_16x16x32_bf16 v[24:27], a[20:23], a[116:119], v[24:27]
    v_mfma_f32_16x16x32_bf16 v[28:31], a[24:27], a[96:99], 0
    v_mfma_f32_16x16x32_bf16 v[28:31], a[28:31], a[100:103], v[28:31]
    v_mfma_f32_16x16x32_bf16 v[28:31], a[32:35], a[104:107], v[28:31]
    v_mfma_f32_16x16x32_bf16 v[28:31], a[36:39], a[108:111], v[28:31]
    v_mfma_f32_16x16x32_bf16 v[28:31], a[40:43], a[112:115], v[28:31]
    v_mfma_f32_16x16x32_bf16 v[28:31], a[44:47], a[116:119], v[28:31]
    v_mfma_f32_16x16x32_bf16 v[32:35], a[48:51], a[96:99], 0
    v_mfma_f32_16x16x32_bf16 v[32:35], a[52:55], a[100:103], v[32:35]
    v_mfma_f32_16x16x32_bf16 v[32:35], a[56:59], a[104:107], v[32:35]
    v_mfma_f32_16x16x32_bf16 v[32:35], a[60:63], a[108:111], v[32:35]
    buffer_store_dwordx4 v[68:71], v11, s[8:11], s19 offen offset:384 sc1
    v_mfma_f32_16x16x32_bf16 v[32:35], a[64:67], a[112:115], v[32:35]
    v_mfma_f32_16x16x32_bf16 v[32:35], a[68:71], a[116:119], v[32:35]
    v_mfma_f32_16x16x32_bf16 v[36:39], a[72:75], a[96:99], 0
    v_mfma_f32_16x16x32_bf16 v[36:39], a[76:79], a[100:103], v[36:39]
    v_mfma_f32_16x16x32_bf16 v[36:39], a[80:83], a[104:107], v[36:39]
    v_mfma_f32_16x16x32_bf16 v[36:39], a[84:87], a[108:111], v[36:39]
    v_mfma_f32_16x16x32_bf16 v[36:39], a[88:91], a[112:115], v[36:39]
    v_mfma_f32_16x16x32_bf16 v[36:39], a[92:95], a[116:119], v[36:39]
    buffer_store_dwordx4 v[72:75], v11, s[8:11], s19 offen offset:768 sc1
    s_setprio 0
    s_barrier
    v_max3_f32 v14, v24, v25, v26
    v_max3_f32 v15, v27, v28, v29
    v_max3_f32 v14, v14, v30, v31
    v_max3_f32 v15, v15, v32, v33
    v_max3_f32 v14, v14, v34, v35
    v_max3_f32 v15, v15, v36, v37
    v_max3_f32 v14, v14, v38, v39
    v_max_f32 v14, v14, v15
    v_mov_b32 v15, v14
    s_nop 1
    v_permlane32_swap_b32 v14, v15
    v_max_f32 v14, v14, v15
    v_mov_b32 v15, v14
    s_nop 1
    v_permlane16_swap_b32 v14, v15
    v_max_f32 v14, v14, v15
    v_sub_f32 v24, v24, v14
    v_sub_f32 v25, v25, v14
    v_sub_f32 v26, v26, v14
    v_sub_f32 v27, v27, v14
    v_sub_f32 v28, v28, v14
    v_sub_f32 v29, v29, v14
    v_sub_f32 v30, v30, v14
    v_sub_f32 v31, v31, v14
    v_sub_f32 v32, v32, v14
    v_sub_f32 v33, v33, v14
    v_sub_f32 v34, v34, v14
    buffer_store_dwordx4 v[76:79], v11, s[8:11], s19 offen offset:1152 sc1
    v_sub_f32 v35, v35, v14
    v_sub_f32 v36, v36, v14
    v_sub_f32 v37, v37, v14
    v_sub_f32 v38, v38, v14
    v_sub_f32 v39, v39, v14
    v_exp_f32 v24, v24
    v_exp_f32 v25, v25
    v_exp_f32 v26, v26
    v_exp_f32 v27, v27
    v_exp_f32 v28, v28
    v_exp_f32 v29, v29
    v_exp_f32 v30, v30
    v_exp_f32 v31, v31
    v_exp_f32 v32, v32
    v_exp_f32 v33, v33
    v_exp_f32 v34, v34
    v_exp_f32 v35, v35
    v_exp_f32 v36, v36
    v_exp_f32 v37, v37
    v_exp_f32 v38, v38
    v_exp_f32 v39, v39
    v_add_f32 v16, v24, v25
    v_add_f32 v17, v26, v27
    v_add_f32 v16, v16, v28
    ds_read_b128 a[120:123], v10 offset:0
    v_add_f32 v17, v17, v29
    v_add_f32 v16, v16, v30
    v_add_f32 v17, v17, v31
    v_add_f32 v16, v16, v32
    ds_read_b128 a[124:127], v10 offset:1024
    v_add_f32 v17, v17, v33
    v_add_f32 v16, v16, v34
    v_add_f32 v17, v17, v35
    v_add_f32 v16, v16, v36
    buffer_store_dwordx2 v[80:81], v12, s[8:11], s19 offen offset:0 sc1
    ds_read_b128 a[128:131], v10 offset:2048
    v_add_f32 v17, v17, v37
    v_add_f32 v16, v16, v38
    v_add_f32 v17, v17, v39
    v_add_f32 v16, v16, v17
    ds_read_b128 a[132:135], v10 offset:3072
    v_mov_b32 v15, v16
    s_nop 1
    v_permlane32_swap_b32 v16, v15
    v_add_f32 v16, v16, v15
    v_mov_b32 v15, v16
    ds_read_b128 a[136:139], v10 offset:4096
    s_nop 0
    v_permlane16_swap_b32 v16, v15
    v_add_f32 v16, v16, v15
    v_rcp_f32 v16, v16
    s_nop 0
    v_mul_f32 v24, v24, v16
    ds_read_b128 a[140:143], v10 offset:5120
    v_mul_f32 v25, v25, v16
    v_mul_f32 v26, v26, v16
    v_mul_f32 v27, v27, v16
    v_mul_f32 v28, v28, v16
    buffer_store_dwordx2 v[82:83], v12, s[8:11], s19 offen offset:384 sc1
    ds_read_b128 a[144:147], v10 offset:6144
    v_mul_f32 v29, v29, v16
    v_mul_f32 v30, v30, v16
    v_mul_f32 v31, v31, v16
    v_mul_f32 v32, v32, v16
    ds_read_b128 a[148:151], v10 offset:7168
    v_mul_f32 v33, v33, v16
    v_mul_f32 v34, v34, v16
    v_mul_f32 v35, v35, v16
    v_mul_f32 v36, v36, v16
    v_mul_f32 v37, v37, v16
    v_mul_f32 v38, v38, v16
    v_mul_f32 v39, v39, v16
    v_cvt_pk_bf16_f32 v40, v24, v25
    v_cvt_pk_bf16_f32 v41, v26, v27
    v_cvt_pk_bf16_f32 v42, v28, v29
    v_cvt_pk_bf16_f32 v43, v30, v31
    v_cvt_pk_bf16_f32 v44, v32, v33
    v_cvt_pk_bf16_f32 v45, v34, v35
    v_cvt_pk_bf16_f32 v46, v36, v37
    v_cvt_pk_bf16_f32 v47, v38, v39
    s_setprio 2
    s_waitcnt lgkmcnt(7)
    v_mfma_f32_16x16x32_bf16 v[48:51], v[40:43], a[120:123], 0
    ds_read_b128 a[120:123], v10 offset:8192
    s_waitcnt lgkmcnt(7)
    v_mfma_f32_16x16x32_bf16 v[48:51], v[44:47], a[124:127], v[48:51]
    ds_read_b128 a[124:127], v10 offset:9216
    s_waitcnt lgkmcnt(7)
    v_mfma_f32_16x16x32_bf16 v[52:55], v[40:43], a[128:131], 0
    ds_read_b128 a[128:131], v10 offset:10240
    s_waitcnt lgkmcnt(7)
    v_mfma_f32_16x16x32_bf16 v[52:55], v[44:47], a[132:135], v[52:55]
    ds_read_b128 a[132:135], v10 offset:11264
    s_waitcnt lgkmcnt(7)
    v_mfma_f32_16x16x32_bf16 v[56:59], v[40:43], a[136:139], 0
    ds_read_b128 a[136:139], v10 offset:12288
    s_waitcnt lgkmcnt(7)
    v_mfma_f32_16x16x32_bf16 v[56:59], v[44:47], a[140:143], v[56:59]
    ds_read_b128 a[140:143], v10 offset:13312
    v_cvt_pk_bf16_f32 v64, v48, v52
    s_waitcnt lgkmcnt(7)
    v_mfma_f32_16x16x32_bf16 v[60:63], v[40:43], a[144:147], 0
    ds_read_b128 a[144:147], v10 offset:14336
    v_cvt_pk_bf16_f32 v68, v49, v53
    s_waitcnt lgkmcnt(7)
    v_mfma_f32_16x16x32_bf16 v[60:63], v[44:47], a[148:151], v[60:63]
    ds_read_b128 a[148:151], v10 offset:15360
    v_cvt_pk_bf16_f32 v72, v50, v54
    v_cvt_pk_bf16_f32 v76, v51, v55
    s_waitcnt lgkmcnt(7)
    v_mfma_f32_16x16x32_bf16 v[48:51], v[40:43], a[120:123], 0
    ds_read_b128 a[120:123], v10 offset:16384
    buffer_store_dwordx2 v[84:85], v12, s[8:11], s19 offen offset:768 sc1
    s_waitcnt lgkmcnt(7)
    v_mfma_f32_16x16x32_bf16 v[48:51], v[44:47], a[124:127], v[48:51]
    ds_read_b128 a[124:127], v10 offset:17408
    v_cvt_pk_bf16_f32 v65, v56, v60
    s_waitcnt lgkmcnt(7)
    v_mfma_f32_16x16x32_bf16 v[52:55], v[40:43], a[128:131], 0
    ds_read_b128 a[128:131], v10 offset:18432
    v_cvt_pk_bf16_f32 v69, v57, v61
    s_waitcnt lgkmcnt(7)
    v_mfma_f32_16x16x32_bf16 v[52:55], v[44:47], a[132:135], v[52:55]
    ds_read_b128 a[132:135], v10 offset:19456
    v_cvt_pk_bf16_f32 v73, v58, v62
    v_cvt_pk_bf16_f32 v77, v59, v63
    s_waitcnt lgkmcnt(7)
    v_mfma_f32_16x16x32_bf16 v[56:59], v[40:43], a[136:139], 0
    ds_read_b128 a[136:139], v10 offset:20480
    buffer_store_dwordx2 v[86:87], v12, s[8:11], s19 offen offset:1152 sc1
    s_waitcnt lgkmcnt(7)
    v_mfma_f32_16x16x32_bf16 v[56:59], v[44:47], a[140:143], v[56:59]
    ds_read_b128 a[140:143], v10 offset:21504
    v_cvt_pk_bf16_f32 v66, v48, v52
    s_waitcnt lgkmcnt(7)
    v_mfma_f32_16x16x32_bf16 v[60:63], v[40:43], a[144:147], 0
    ds_read_b128 a[144:147], v10 offset:22528
    v_cvt_pk_bf16_f32 v70, v49, v53
    s_waitcnt lgkmcnt(7)
    v_mfma_f32_16x16x32_bf16 v[60:63], v[44:47], a[148:151], v[60:63]
    ds_read_b128 a[148:151], v10 offset:23552
    v_cvt_pk_bf16_f32 v74, v50, v54
    v_cvt_pk_bf16_f32 v78, v51, v55
    s_waitcnt lgkmcnt(7)
    v_mfma_f32_16x16x32_bf16 v[48:51], v[40:43], a[120:123], 0
    s_waitcnt lgkmcnt(6)
    v_mfma_f32_16x16x32_bf16 v[48:51], v[44:47], a[124:127], v[48:51]
    v_cvt_pk_bf16_f32 v67, v56, v60
    v_cvt_pk_bf16_f32 v71, v57, v61
    s_waitcnt lgkmcnt(5)
    v_mfma_f32_16x16x32_bf16 v[52:55], v[40:43], a[128:131], 0
    v_cvt_pk_bf16_f32 v75, v58, v62
    v_cvt_pk_bf16_f32 v79, v59, v63
    buffer_store_dwordx4 v[64:67], v11, s[8:11], s18 offen offset:0 sc1
    buffer_store_dwordx4 v[68:71], v11, s[8:11], s18 offen offset:384 sc1
    buffer_store_dwordx4 v[72:75], v11, s[8:11], s18 offen offset:768 sc1
    buffer_store_dwordx4 v[76:79], v11, s[8:11], s18 offen offset:1152 sc1
    s_waitcnt lgkmcnt(4)
    v_mfma_f32_16x16x32_bf16 v[52:55], v[44:47], a[132:135], v[52:55]
    s_waitcnt lgkmcnt(3)
    v_mfma_f32_16x16x32_bf16 v[56:59], v[40:43], a[136:139], 0
    s_waitcnt lgkmcnt(2)
    v_mfma_f32_16x16x32_bf16 v[56:59], v[44:47], a[140:143], v[56:59]
    v_cvt_pk_bf16_f32 v80, v48, v52
    v_cvt_pk_bf16_f32 v82, v49, v53
    s_waitcnt lgkmcnt(1)
    v_mfma_f32_16x16x32_bf16 v[60:63], v[40:43], a[144:147], 0
    v_cvt_pk_bf16_f32 v84, v50, v54
    v_cvt_pk_bf16_f32 v86, v51, v55
    s_waitcnt lgkmcnt(0)
    v_mfma_f32_16x16x32_bf16 v[60:63], v[44:47], a[148:151], v[60:63]
    s_nop 7
    v_cvt_pk_bf16_f32 v81, v56, v60
    v_cvt_pk_bf16_f32 v83, v57, v61
    v_cvt_pk_bf16_f32 v85, v58, v62
    v_cvt_pk_bf16_f32 v87, v59, v63
    buffer_store_dwordx2 v[80:81], v12, s[8:11], s18 offen offset:0 sc1
    buffer_store_dwordx2 v[82:83], v12, s[8:11], s18 offen offset:384 sc1
    buffer_store_dwordx2 v[84:85], v12, s[8:11], s18 offen offset:768 sc1
    buffer_store_dwordx2 v[86:87], v12, s[8:11], s18 offen offset:1152 sc1
    s_endpgm
L_main_done:
    s_endpgm
.section .rodata,"a"
.p2align 6
.amdhsa_kernel swin_fold_kernel
  .amdhsa_next_free_vgpr 144
  .amdhsa_next_free_sgpr 64
  .amdhsa_accum_offset 144
  .amdhsa_group_segment_fixed_size 0
  .amdhsa_kernarg_size 48
  .amdhsa_user_sgpr_count 2
  .amdhsa_user_sgpr_kernarg_segment_ptr 1
  .amdhsa_system_sgpr_workgroup_id_x 1
.end_amdhsa_kernel
.p2align 6
.amdhsa_kernel standalone__swin_window_attn__vision_kernel
  .amdhsa_next_free_vgpr 256
  .amdhsa_next_free_sgpr 96
  .amdhsa_accum_offset 96
  .amdhsa_group_segment_fixed_size 0
  .amdhsa_kernarg_size 48
  .amdhsa_user_sgpr_count 2
  .amdhsa_user_sgpr_kernarg_segment_ptr 1
  .amdhsa_system_sgpr_workgroup_id_x 1
.end_amdhsa_kernel
```
